```python
import torch

def _softmax(x, axis=-1):
    return torch.softmax(x, dim=axis)
def _gelu(x):
    return torch.nn.functional.gelu(x, approximate="tanh")
def _silu(x):
    return torch.nn.functional.silu(x)
def _sigmoid(x):
    return torch.sigmoid(x)
def _layernorm(x, axis=-1, eps=1e-5):
    m = x.mean(dim=axis, keepdim=True)
    v = x.var(dim=axis, keepdim=True, unbiased=False)
    return (x - m) / torch.sqrt(v + eps)
def _scatter_add(tgt, idx, src, axis=0):
    return tgt.clone().index_add_(axis, idx, src)
def _segment_sum(src, seg, n):
    out = torch.zeros((n,) + src.shape[1:], dtype=src.dtype)
    return out.index_add_(0, seg, src)
def _pad(x, pw):
    flat = tuple(v for pair in reversed(pw) for v in pair)
    return torch.nn.functional.pad(x, flat)

kernel_name = 'concat_heads__linear_attn_block__ssm_conv_s4d__prompt'

def setup_inputs():

    _w = (lambda a: (lambda t: t.to(torch.bfloat16) if t.is_floating_point() else t)(torch.as_tensor(a)))
    def _A_setup():
        B, S, D = 1, 2048, 448
        return {
            "x": _w((lambda *s: torch.randn(*s, dtype=torch.bfloat16) * 0.05)(B, S, D)),
            "wqkv": _w((lambda *s: torch.randn(*s, dtype=torch.bfloat16) * 0.8)(D, 3 * D)),
            "wo": _w((lambda *s: torch.randn(*s, dtype=torch.bfloat16) * 0.05)(D, D)),
        }
    _A_in = _A_setup()

    def _B_setup():
        Bsz, L, D, N = 1, 2048, 448, 256
        return {
            "u": _w((lambda *s: torch.randn(*s, dtype=torch.bfloat16) * 0.05)(Bsz, L, D)),
            "log_A_real": _w((lambda *s: torch.randn(*s, dtype=torch.bfloat16) * 3.2)(D, N) * 0.5),
            "A_imag": _w((lambda *s: torch.randn(*s, dtype=torch.bfloat16) * 0.05)(D, N) * 3.14),
            "C_real": _w((lambda *s: torch.randn(*s, dtype=torch.bfloat16) * 0.2)(D, N) / N ** 0.5),
            "C_imag": _w((lambda *s: torch.randn(*s, dtype=torch.bfloat16) * 0.4)(D, N) / N ** 0.5),
            "log_dt": _w((lambda *s: torch.randn(*s, dtype=torch.bfloat16) * 0.05)(D) * 0.5 - 4.0),
            "D_skip": _w((lambda *s: torch.randn(*s, dtype=torch.bfloat16) * 0.05)(D)),
        }
    _B_in = _B_setup()

    return {
        "A_x": _A_in["x"],
        "A_wqkv": _A_in["wqkv"],
        "A_wo": _A_in["wo"],
        "B_u": _B_in["u"],
        "B_log_A_real": _B_in["log_A_real"],
        "B_A_imag": _B_in["A_imag"],
        "B_C_real": _B_in["C_real"],
        "B_C_imag": _B_in["C_imag"],
        "B_log_dt": _B_in["log_dt"],
        "B_D_skip": _B_in["D_skip"],
    }

def reference(A_x, A_wqkv, A_wo, B_u, B_log_A_real, B_A_imag, B_C_real, B_C_imag, B_log_dt, B_D_skip):
    def _A_ref(x, wqkv, wo):
        B, S, D = x.shape
        H = 16; Dh = D // H
        qkv = (lambda x, *d: x.permute(*d))((x @ wqkv).reshape(B, S, 3, H, Dh), 2, 0, 3, 1, 4)
        q, k, v = qkv[0], qkv[1], qkv[2]
        phi = lambda t: torch.where(t > 0, t + 1, torch.exp(t)) + 1e-6
        pq, pk = phi(q), phi(k)
        kv = torch.einsum("bhsd,bhse->bhde", pk, v)
        z = torch.einsum("bhsd->bhd", pk)
        num = torch.einsum("bhqd,bhde->bhqe", pq, kv)
        den = torch.einsum("bhqd,bhd->bhq", pq, z)[..., None] + 1e-6
        o = num / den
        return (lambda x, *d: x.permute(*d))(o, 0, 2, 1, 3).reshape(B, S, D) @ wo

    def _B_ref(u, log_A_real, A_imag, C_real, C_imag, log_dt, D_skip):
        L = u.shape[1]
        dt = torch.exp(log_dt)
        A = -torch.exp(log_A_real) + 1j * A_imag
        C = (C_real + 1j * C_imag) * dt[:, None]
        pos = (lambda x, dt: x.to(dt))(torch.arange(L), log_dt.dtype)
        P = torch.exp((A * dt[:, None])[:, :, None] * pos[None, None, :])
        K = 2.0 * torch.einsum("dn,dnl->dl", C, P).real
        L2 = 2 * L
        u_t = (lambda x, *d: x.permute(*d))(u, 0, 2, 1)
        Kf = (lambda x, *a, **k: torch.fft.rfft(x.float(), *a, **k))(K, L2)
        Uf = (lambda x, *a, **k: torch.fft.rfft(x.float(), *a, **k))(u_t, L2)
        y = (lambda x, *a, **k: torch.fft.irfft(x, *a, **k).to(torch.bfloat16))(Uf * Kf[None, :, :], L2)[:, :, :L]
        y = (lambda x, *d: x.permute(*d))(y, 0, 2, 1)
        return y + u * D_skip[None, None, :]

    a = _A_ref(A_x, A_wqkv, A_wo)
    b = _B_ref(B_u, B_log_A_real, B_A_imag, B_C_real, B_C_imag, B_log_dt, B_D_skip)
    return torch.concatenate([a, b], axis=-1)
```

```asm
; @launch grid=(464,1,1) block=(512,1,1) lds=81920
.amdgcn_target "amdgcn-amd-amdhsa--gfx950"
.text
.globl concat_heads__linear_attn_block__ssm_conv_s4d__prompt_kernel
.p2align 8
.type concat_heads__linear_attn_block__ssm_conv_s4d__prompt_kernel,@function
concat_heads__linear_attn_block__ssm_conv_s4d__prompt_kernel:
    s_cmp_ge_u32 s2, 464
    s_cbranch_scc1 K_exit
    s_load_dwordx16 s[16:31], s[0:1], 0
    s_load_dwordx8 s[32:39], s[0:1], 64
    s_load_dwordx2 s[40:41], s[0:1], 96
    s_and_b32 s3, s2, 7
    s_lshr_b32 s4, s2, 3
    v_lshrrev_b32 v1, 6, v0
    v_and_b32 v7, 63, v0
    v_readfirstlane_b32 s5, v1
    s_nop 3
    s_cmp_lt_u32 s4, 28
    s_cbranch_scc1 B_entry
    s_setprio 2
    s_cmp_ge_u32 s4, 44
    s_cbranch_scc1 Q_entry
    s_and_b32 s14, s3, 1
    s_sub_u32 s7, s4, 28
    s_lshr_b32 s6, s7, 2
    s_and_b32 s7, s7, 3
    s_lshl_b32 s15, s14, 2
    s_add_u32 s12, s7, s15
    s_mul_i32 s9, s12, 112
    s_add_u32 s9, s9, 896
    s_lshr_b32 s11, s3, 1
    s_lshl_b32 s11, s11, 2
    s_add_u32 s11, s11, s6
    s_lshl_b32 s6, s11, 3
    s_add_u32 s6, s6, s5
    s_mul_i32 s76, s6, 14336
    s_add_u32 s77, s76, 7168
    s_lshl_b32 s100, s2, 7
    s_and_b32 s6, s11, 3
    s_lshl_b32 s6, s6, 1
    s_and_b32 s7, s12, 3
    s_add_u32 s6, s6, s7
    s_cmp_ge_u32 s6, 7
    s_cselect_b32 s7, 7, 0
    s_sub_u32 s6, s6, s7
    s_lshl_b32 s69, s6, 7
    s_mul_i32 s68, s6, 172032
    v_and_b32 v24, 15, v7
    v_lshrrev_b32 v25, 4, v7
    v_lshrrev_b32 v16, 3, v7
    v_and_b32 v17, 7, v7
    v_xor_b32 v17, v17, v16
    v_mul_u32_u24 v18, 896, v16
    v_lshl_add_u32 v1, v17, 4, v18
    s_lshl_b32 s78, s5, 11
    s_add_u32 s78, s78, 32768
    s_and_b32 s6, s5, 2
    s_lshl_b32 s6, s6, 1
    v_or_b32 v20, s6, v25
    v_lshrrev_b32 v21, 1, v24
    v_xor_b32 v21, v21, v20
    v_and_b32 v22, 1, v24
    v_lshl_or_b32 v21, v21, 1, v22
    v_lshrrev_b32 v22, 3, v21
    v_and_b32 v21, 7, v21
    v_min_u32 v21, 6, v21
    s_lshl_b32 s6, s5, 2
    v_add_u32 v23, s6, v25
    v_mul_u32_u24 v23, 2688, v23
    v_mul_u32_u24 v22, 896, v22
    v_lshl_add_u32 v23, v21, 4, v23
    v_add_u32 v6, v23, v22
    s_lshl_b32 s8, s5, 10
    v_mov_b32 v0, s100
    s_waitcnt lgkmcnt(0)
    s_mov_b32 s44, s16
    s_mov_b32 s45, s17
    s_mov_b32 s46, 0x1c0000
    s_mov_b32 s47, 0x00020000
    s_mov_b32 s48, s18
    s_mov_b32 s49, s19
    s_mov_b32 s50, 0x126000
    s_mov_b32 s51, 0x00020000
    s_add_u32 s56, s40, 0x400000
    s_addc_u32 s57, s41, 0
    s_mov_b32 s58, 0x12000
    s_mov_b32 s59, 0x00020000
    s_add_u32 m0, s78, 0
    s_add_u32 s10, s76, s69
    buffer_load_dwordx4 v1, s[44:47], s10 offen lds
    s_add_u32 m0, s78, 1024
    s_add_u32 s10, s77, s69
    buffer_load_dwordx4 v1, s[44:47], s10 offen lds
    s_add_u32 s69, s69, 128
    s_cmp_ge_u32 s69, 896
    s_cselect_b32 s69, 0, s69
    s_add_u32 m0, s8, 0
    s_add_u32 s10, s9, s68
    buffer_load_dwordx4 v6, s[48:51], s10 offen lds
    s_add_u32 s68, s68, 86016
    s_cmp_ge_u32 s68, 1204224
    s_cselect_b32 s68, 0, s68
    s_barrier
    s_add_u32 m0, s8, 8192
    s_add_u32 s10, s9, s68
    buffer_load_dwordx4 v6, s[48:51], s10 offen lds
    s_add_u32 s68, s68, 86016
    s_cmp_ge_u32 s68, 1204224
    s_cselect_b32 s68, 0, s68
    s_add_u32 m0, s78, 16384
    s_add_u32 s10, s76, s69
    buffer_load_dwordx4 v1, s[44:47], s10 offen lds
    s_add_u32 m0, s78, 17408
    s_add_u32 s10, s77, s69
    buffer_load_dwordx4 v1, s[44:47], s10 offen lds
    s_add_u32 s69, s69, 128
    s_cmp_ge_u32 s69, 896
    s_cselect_b32 s69, 0, s69
    s_barrier
    s_add_u32 m0, s8, 16384
    s_add_u32 s10, s9, s68
    buffer_load_dwordx4 v6, s[48:51], s10 offen lds
    s_add_u32 s68, s68, 86016
    s_cmp_ge_u32 s68, 1204224
    s_cselect_b32 s68, 0, s68
    s_add_u32 m0, s8, 24576
    s_add_u32 s10, s9, s68
    buffer_load_dwordx4 v6, s[48:51], s10 offen lds
    s_add_u32 s68, s68, 86016
    s_cmp_ge_u32 s68, 1204224
    s_cselect_b32 s68, 0, s68
    s_add_u32 m0, s78, 32768
    s_add_u32 s10, s76, s69
    buffer_load_dwordx4 v1, s[44:47], s10 offen lds
    s_add_u32 m0, s78, 33792
    s_add_u32 s10, s77, s69
    buffer_load_dwordx4 v1, s[44:47], s10 offen lds
    s_add_u32 s69, s69, 128
    s_cmp_ge_u32 s69, 896
    s_cselect_b32 s69, 0, s69
    s_add_u32 s72, s40, 0x480000
    s_addc_u32 s73, s41, 0
    s_mov_b32 s74, 0x20000
    s_mov_b32 s75, 0x00020000
    buffer_load_dwordx2 v[12:13], v0, s[72:75], 0 offen sc1
    s_mov_b32 s64, s38
    s_mov_b32 s65, s39
    s_mov_b32 s66, 0x100
    s_mov_b32 s67, 0x00020000
    s_mov_b32 s52, s40
    s_mov_b32 s53, s41
    s_mov_b32 s54, 0x1c0000
    s_mov_b32 s55, 0x00020000
    s_lshr_b32 s6, s5, 1
    s_lshl_b32 s6, s6, 12
    s_add_u32 s6, s6, 32768
    v_and_b32 v16, 7, v24
    v_xor_b32 v16, v16, v25
    v_lshlrev_b32 v16, 4, v16
    v_lshl_add_u32 v16, v24, 7, v16
    v_xor_b32 v17, 64, v16
    v_add_u32 v3, s6, v16
    v_add_u32 v4, s6, v17
    v_bfe_u32 v16, v7, 2, 2
    v_and_b32 v17, 3, v7
    v_and_b32 v18, 1, v25
    v_lshl_or_b32 v18, v18, 2, v16
    v_lshl_add_u32 v19, v25, 3, v16
    v_lshlrev_b32 v19, 8, v19
    s_and_b32 s7, s5, 1
    s_mul_i32 s6, s7, 48
    s_add_u32 s6, s6, 0
    v_lshlrev_b32 v20, 3, v17
    v_add_u32 v20, s6, v20
    v_lshrrev_b32 v21, 5, v20
    v_xor_b32 v21, v21, v18
    v_and_b32 v20, 31, v20
    v_lshl_or_b32 v20, v21, 5, v20
    v_add_u32 v8, v20, v19
    s_mul_i32 s6, s7, 48
    s_add_u32 s6, s6, 32
    v_lshlrev_b32 v20, 3, v17
    v_add_u32 v20, s6, v20
    v_lshrrev_b32 v21, 5, v20
    v_xor_b32 v21, v21, v18
    v_and_b32 v20, 31, v20
    v_lshl_or_b32 v20, v21, 5, v20
    v_add_u32 v9, v20, v19
    s_mul_i32 s6, s7, 56
    s_add_u32 s6, s6, 128
    v_lshlrev_b32 v20, 3, v17
    v_add_u32 v20, s6, v20
    v_lshrrev_b32 v21, 5, v20
    v_xor_b32 v21, v21, v18
    v_and_b32 v20, 31, v20
    v_lshl_or_b32 v20, v21, 5, v20
    v_add_u32 v10, v20, v19
    s_mul_i32 s6, s7, 56
    s_add_u32 s6, s6, 160
    v_lshlrev_b32 v20, 3, v17
    v_add_u32 v20, s6, v20
    v_lshrrev_b32 v21, 5, v20
    v_xor_b32 v21, v21, v18
    v_and_b32 v20, 31, v20
    v_lshl_or_b32 v20, v21, 5, v20
    v_add_u32 v11, v20, v19
    s_mov_b32 s14, 0x3fb8aa3b
    s_mov_b32 s15, 0x3fb8aa3b
    s_mov_b32 s13, 0x358637bd
    s_waitcnt vmcnt(8)
    s_barrier
    ds_read_b128 v[32:35], v3 offset:0
    ds_read_b128 v[36:39], v3 offset:2048
    ds_read_b64_tr_b16 v[16:17], v8 offset:0
    ds_read_b64_tr_b16 v[18:19], v8 offset:1024
    ds_read_b64_tr_b16 v[20:21], v9 offset:0
    ds_read_b64_tr_b16 v[22:23], v9 offset:1024
    ds_read_b64_tr_b16 v[24:25], v10 offset:0
    ds_read_b64_tr_b16 v[26:27], v10 offset:1024
    ds_read_b64_tr_b16 v[28:29], v11 offset:0
    ds_read_b64_tr_b16 v[30:31], v11 offset:1024
    s_waitcnt lgkmcnt(0)
    v_mfma_f32_16x16x32_bf16 v[64:67], v[32:35], v[16:19], 0
    v_mfma_f32_16x16x32_bf16 v[68:71], v[36:39], v[16:19], 0
    s_waitcnt vmcnt(7)
    s_barrier
    s_add_u32 m0, s8, 0
    s_add_u32 s10, s9, s68
    buffer_load_dwordx4 v6, s[48:51], s10 offen lds
    s_add_u32 s68, s68, 86016
    s_cmp_ge_u32 s68, 1204224
    s_cselect_b32 s68, 0, s68
    ds_read_b128 v[56:59], v4 offset:0
    ds_read_b128 v[60:63], v4 offset:2048
    v_mfma_f32_16x16x32_bf16 v[72:75], v[32:35], v[20:23], 0
    ds_read_b64_tr_b16 v[40:41], v8 offset:8192
    ds_read_b64_tr_b16 v[42:43], v8 offset:9216
    v_mfma_f32_16x16x32_bf16 v[76:79], v[36:39], v[20:23], 0
    ds_read_b64_tr_b16 v[44:45], v9 offset:8192
    ds_read_b64_tr_b16 v[46:47], v9 offset:9216
    v_mfma_f32_16x16x32_bf16 v[80:83], v[32:35], v[24:27], 0
    ds_read_b64_tr_b16 v[48:49], v10 offset:8192
    ds_read_b64_tr_b16 v[50:51], v10 offset:9216
    v_mfma_f32_16x16x32_bf16 v[84:87], v[36:39], v[24:27], 0
    ds_read_b64_tr_b16 v[52:53], v11 offset:8192
    ds_read_b64_tr_b16 v[54:55], v11 offset:9216
    v_mfma_f32_16x16x32_bf16 v[88:91], v[32:35], v[28:31], 0
    v_mfma_f32_16x16x32_bf16 v[92:95], v[36:39], v[28:31], 0
    s_waitcnt lgkmcnt(0)
    v_mfma_f32_16x16x32_bf16 v[64:67], v[56:59], v[40:43], v[64:67]
    v_mfma_f32_16x16x32_bf16 v[68:71], v[60:63], v[40:43], v[68:71]
    s_waitcnt vmcnt(5)
    s_barrier
    s_add_u32 m0, s8, 8192
    s_add_u32 s10, s9, s68
    buffer_load_dwordx4 v6, s[48:51], s10 offen lds
    s_add_u32 s68, s68, 86016
    s_cmp_ge_u32 s68, 1204224
    s_cselect_b32 s68, 0, s68
    s_add_u32 m0, s78, 0
    s_add_u32 s10, s76, s69
    buffer_load_dwordx4 v1, s[44:47], s10 offen lds
    s_add_u32 m0, s78, 1024
    s_add_u32 s10, s77, s69
    buffer_load_dwordx4 v1, s[44:47], s10 offen lds
    s_add_u32 s69, s69, 128
    s_cmp_ge_u32 s69, 896
    s_cselect_b32 s69, 0, s69
    ds_read_b128 v[32:35], v3 offset:16384
    ds_read_b128 v[36:39], v3 offset:18432
    v_mfma_f32_16x16x32_bf16 v[72:75], v[56:59], v[44:47], v[72:75]
    ds_read_b64_tr_b16 v[16:17], v8 offset:16384
    ds_read_b64_tr_b16 v[18:19], v8 offset:17408
    v_mfma_f32_16x16x32_bf16 v[76:79], v[60:63], v[44:47], v[76:79]
    ds_read_b64_tr_b16 v[20:21], v9 offset:16384
    ds_read_b64_tr_b16 v[22:23], v9 offset:17408
    v_mfma_f32_16x16x32_bf16 v[80:83], v[56:59], v[48:51], v[80:83]
    ds_read_b64_tr_b16 v[24:25], v10 offset:16384
    ds_read_b64_tr_b16 v[26:27], v10 offset:17408
    v_mfma_f32_16x16x32_bf16 v[84:87], v[60:63], v[48:51], v[84:87]
    ds_read_b64_tr_b16 v[28:29], v11 offset:16384
    ds_read_b64_tr_b16 v[30:31], v11 offset:17408
    v_mfma_f32_16x16x32_bf16 v[88:91], v[56:59], v[52:55], v[88:91]
    v_mfma_f32_16x16x32_bf16 v[92:95], v[60:63], v[52:55], v[92:95]
    s_waitcnt lgkmcnt(0)
    v_mfma_f32_16x16x32_bf16 v[64:67], v[32:35], v[16:19], v[64:67]
    v_mfma_f32_16x16x32_bf16 v[68:71], v[36:39], v[16:19], v[68:71]
    s_waitcnt vmcnt(7)
    s_barrier
    s_add_u32 m0, s8, 16384
    s_add_u32 s10, s9, s68
    buffer_load_dwordx4 v6, s[48:51], s10 offen lds
    s_add_u32 s68, s68, 86016
    s_cmp_ge_u32 s68, 1204224
    s_cselect_b32 s68, 0, s68
    ds_read_b128 v[56:59], v4 offset:16384
    ds_read_b128 v[60:63], v4 offset:18432
    v_mfma_f32_16x16x32_bf16 v[72:75], v[32:35], v[20:23], v[72:75]
    ds_read_b64_tr_b16 v[40:41], v8 offset:24576
    ds_read_b64_tr_b16 v[42:43], v8 offset:25600
    v_mfma_f32_16x16x32_bf16 v[76:79], v[36:39], v[20:23], v[76:79]
    ds_read_b64_tr_b16 v[44:45], v9 offset:24576
    ds_read_b64_tr_b16 v[46:47], v9 offset:25600
    v_mfma_f32_16x16x32_bf16 v[80:83], v[32:35], v[24:27], v[80:83]
    ds_read_b64_tr_b16 v[48:49], v10 offset:24576
    ds_read_b64_tr_b16 v[50:51], v10 offset:25600
    v_mfma_f32_16x16x32_bf16 v[84:87], v[36:39], v[24:27], v[84:87]
    ds_read_b64_tr_b16 v[52:53], v11 offset:24576
    ds_read_b64_tr_b16 v[54:55], v11 offset:25600
    v_mfma_f32_16x16x32_bf16 v[88:91], v[32:35], v[28:31], v[88:91]
    v_mfma_f32_16x16x32_bf16 v[92:95], v[36:39], v[28:31], v[92:95]
    s_waitcnt lgkmcnt(0)
    v_mfma_f32_16x16x32_bf16 v[64:67], v[56:59], v[40:43], v[64:67]
    v_mfma_f32_16x16x32_bf16 v[68:71], v[60:63], v[40:43], v[68:71]
    s_waitcnt vmcnt(4)
    s_barrier
    s_add_u32 m0, s8, 24576
    s_add_u32 s10, s9, s68
    buffer_load_dwordx4 v6, s[48:51], s10 offen lds
    s_add_u32 s68, s68, 86016
    s_cmp_ge_u32 s68, 1204224
    s_cselect_b32 s68, 0, s68
    s_add_u32 m0, s78, 16384
    s_add_u32 s10, s76, s69
    buffer_load_dwordx4 v1, s[44:47], s10 offen lds
    s_add_u32 m0, s78, 17408
    s_add_u32 s10, s77, s69
    buffer_load_dwordx4 v1, s[44:47], s10 offen lds
    s_add_u32 s69, s69, 128
    s_cmp_ge_u32 s69, 896
    s_cselect_b32 s69, 0, s69
    ds_read_b128 v[32:35], v3 offset:32768
    ds_read_b128 v[36:39], v3 offset:34816
    v_mfma_f32_16x16x32_bf16 v[72:75], v[56:59], v[44:47], v[72:75]
    ds_read_b64_tr_b16 v[16:17], v8 offset:0
    ds_read_b64_tr_b16 v[18:19], v8 offset:1024
    v_mfma_f32_16x16x32_bf16 v[76:79], v[60:63], v[44:47], v[76:79]
    ds_read_b64_tr_b16 v[20:21], v9 offset:0
    ds_read_b64_tr_b16 v[22:23], v9 offset:1024
    v_mfma_f32_16x16x32_bf16 v[80:83], v[56:59], v[48:51], v[80:83]
    ds_read_b64_tr_b16 v[24:25], v10 offset:0
    ds_read_b64_tr_b16 v[26:27], v10 offset:1024
    v_mfma_f32_16x16x32_bf16 v[84:87], v[60:63], v[48:51], v[84:87]
    ds_read_b64_tr_b16 v[28:29], v11 offset:0
    ds_read_b64_tr_b16 v[30:31], v11 offset:1024
    v_mfma_f32_16x16x32_bf16 v[88:91], v[56:59], v[52:55], v[88:91]
    v_mfma_f32_16x16x32_bf16 v[92:95], v[60:63], v[52:55], v[92:95]
    s_waitcnt lgkmcnt(0)
    v_mfma_f32_16x16x32_bf16 v[64:67], v[32:35], v[16:19], v[64:67]
    v_mfma_f32_16x16x32_bf16 v[68:71], v[36:39], v[16:19], v[68:71]
    s_waitcnt vmcnt(6)
    s_barrier
    s_add_u32 m0, s8, 0
    s_add_u32 s10, s9, s68
    buffer_load_dwordx4 v6, s[48:51], s10 offen lds
    s_add_u32 s68, s68, 86016
    s_cmp_ge_u32 s68, 1204224
    s_cselect_b32 s68, 0, s68
    ds_read_b128 v[56:59], v4 offset:32768
    ds_read_b128 v[60:63], v4 offset:34816
    v_mfma_f32_16x16x32_bf16 v[72:75], v[32:35], v[20:23], v[72:75]
    ds_read_b64_tr_b16 v[40:41], v8 offset:8192
    ds_read_b64_tr_b16 v[42:43], v8 offset:9216
    v_mfma_f32_16x16x32_bf16 v[76:79], v[36:39], v[20:23], v[76:79]
    ds_read_b64_tr_b16 v[44:45], v9 offset:8192
    ds_read_b64_tr_b16 v[46:47], v9 offset:9216
    v_mfma_f32_16x16x32_bf16 v[80:83], v[32:35], v[24:27], v[80:83]
    ds_read_b64_tr_b16 v[48:49], v10 offset:8192
    ds_read_b64_tr_b16 v[50:51], v10 offset:9216
    v_mfma_f32_16x16x32_bf16 v[84:87], v[36:39], v[24:27], v[84:87]
    ds_read_b64_tr_b16 v[52:53], v11 offset:8192
    ds_read_b64_tr_b16 v[54:55], v11 offset:9216
    v_mfma_f32_16x16x32_bf16 v[88:91], v[32:35], v[28:31], v[88:91]
    v_mfma_f32_16x16x32_bf16 v[92:95], v[36:39], v[28:31], v[92:95]
    s_waitcnt lgkmcnt(0)
    v_mfma_f32_16x16x32_bf16 v[64:67], v[56:59], v[40:43], v[64:67]
    v_mfma_f32_16x16x32_bf16 v[68:71], v[60:63], v[40:43], v[68:71]
    s_waitcnt vmcnt(4)
    s_barrier
    s_add_u32 m0, s8, 8192
    s_add_u32 s10, s9, s68
    buffer_load_dwordx4 v6, s[48:51], s10 offen lds
    s_add_u32 s68, s68, 86016
    s_cmp_ge_u32 s68, 1204224
    s_cselect_b32 s68, 0, s68
    s_add_u32 m0, s78, 32768
    s_add_u32 s10, s76, s69
    buffer_load_dwordx4 v1, s[44:47], s10 offen lds
    s_add_u32 m0, s78, 33792
    s_add_u32 s10, s77, s69
    buffer_load_dwordx4 v1, s[44:47], s10 offen lds
    s_add_u32 s69, s69, 128
    s_cmp_ge_u32 s69, 896
    s_cselect_b32 s69, 0, s69
    ds_read_b128 v[32:35], v3 offset:0
    ds_read_b128 v[36:39], v3 offset:2048
    v_mfma_f32_16x16x32_bf16 v[72:75], v[56:59], v[44:47], v[72:75]
    ds_read_b64_tr_b16 v[16:17], v8 offset:16384
    ds_read_b64_tr_b16 v[18:19], v8 offset:17408
    v_mfma_f32_16x16x32_bf16 v[76:79], v[60:63], v[44:47], v[76:79]
    ds_read_b64_tr_b16 v[20:21], v9 offset:16384
    ds_read_b64_tr_b16 v[22:23], v9 offset:17408
    v_mfma_f32_16x16x32_bf16 v[80:83], v[56:59], v[48:51], v[80:83]
    ds_read_b64_tr_b16 v[24:25], v10 offset:16384
    ds_read_b64_tr_b16 v[26:27], v10 offset:17408
    v_mfma_f32_16x16x32_bf16 v[84:87], v[60:63], v[48:51], v[84:87]
    ds_read_b64_tr_b16 v[28:29], v11 offset:16384
    ds_read_b64_tr_b16 v[30:31], v11 offset:17408
    v_mfma_f32_16x16x32_bf16 v[88:91], v[56:59], v[52:55], v[88:91]
    v_mfma_f32_16x16x32_bf16 v[92:95], v[60:63], v[52:55], v[92:95]
    s_waitcnt lgkmcnt(0)
    v_mfma_f32_16x16x32_bf16 v[64:67], v[32:35], v[16:19], v[64:67]
    v_mfma_f32_16x16x32_bf16 v[68:71], v[36:39], v[16:19], v[68:71]
    s_waitcnt vmcnt(6)
    s_barrier
    s_add_u32 m0, s8, 16384
    s_add_u32 s10, s9, s68
    buffer_load_dwordx4 v6, s[48:51], s10 offen lds
    s_add_u32 s68, s68, 86016
    s_cmp_ge_u32 s68, 1204224
    s_cselect_b32 s68, 0, s68
    ds_read_b128 v[56:59], v4 offset:0
    ds_read_b128 v[60:63], v4 offset:2048
    v_mfma_f32_16x16x32_bf16 v[72:75], v[32:35], v[20:23], v[72:75]
    ds_read_b64_tr_b16 v[40:41], v8 offset:24576
    ds_read_b64_tr_b16 v[42:43], v8 offset:25600
    v_mfma_f32_16x16x32_bf16 v[76:79], v[36:39], v[20:23], v[76:79]
    ds_read_b64_tr_b16 v[44:45], v9 offset:24576
    ds_read_b64_tr_b16 v[46:47], v9 offset:25600
    v_mfma_f32_16x16x32_bf16 v[80:83], v[32:35], v[24:27], v[80:83]
    ds_read_b64_tr_b16 v[48:49], v10 offset:24576
    ds_read_b64_tr_b16 v[50:51], v10 offset:25600
    v_mfma_f32_16x16x32_bf16 v[84:87], v[36:39], v[24:27], v[84:87]
    ds_read_b64_tr_b16 v[52:53], v11 offset:24576
    ds_read_b64_tr_b16 v[54:55], v11 offset:25600
    v_mfma_f32_16x16x32_bf16 v[88:91], v[32:35], v[28:31], v[88:91]
    v_mfma_f32_16x16x32_bf16 v[92:95], v[36:39], v[28:31], v[92:95]
    s_waitcnt lgkmcnt(0)
    v_mfma_f32_16x16x32_bf16 v[64:67], v[56:59], v[40:43], v[64:67]
    v_mfma_f32_16x16x32_bf16 v[68:71], v[60:63], v[40:43], v[68:71]
    s_waitcnt vmcnt(4)
    s_barrier
    s_add_u32 m0, s8, 24576
    s_add_u32 s10, s9, s68
    buffer_load_dwordx4 v6, s[48:51], s10 offen lds
    s_add_u32 s68, s68, 86016
    s_cmp_ge_u32 s68, 1204224
    s_cselect_b32 s68, 0, s68
    s_add_u32 m0, s78, 0
    s_add_u32 s10, s76, s69
    buffer_load_dwordx4 v1, s[44:47], s10 offen lds
    s_add_u32 m0, s78, 1024
    s_add_u32 s10, s77, s69
    buffer_load_dwordx4 v1, s[44:47], s10 offen lds
    s_add_u32 s69, s69, 128
    s_cmp_ge_u32 s69, 896
    s_cselect_b32 s69, 0, s69
    ds_read_b128 v[32:35], v3 offset:16384
    ds_read_b128 v[36:39], v3 offset:18432
    v_mfma_f32_16x16x32_bf16 v[72:75], v[56:59], v[44:47], v[72:75]
    ds_read_b64_tr_b16 v[16:17], v8 offset:0
    ds_read_b64_tr_b16 v[18:19], v8 offset:1024
    v_mfma_f32_16x16x32_bf16 v[76:79], v[60:63], v[44:47], v[76:79]
    ds_read_b64_tr_b16 v[20:21], v9 offset:0
    ds_read_b64_tr_b16 v[22:23], v9 offset:1024
    v_mfma_f32_16x16x32_bf16 v[80:83], v[56:59], v[48:51], v[80:83]
    ds_read_b64_tr_b16 v[24:25], v10 offset:0
    ds_read_b64_tr_b16 v[26:27], v10 offset:1024
    v_mfma_f32_16x16x32_bf16 v[84:87], v[60:63], v[48:51], v[84:87]
    ds_read_b64_tr_b16 v[28:29], v11 offset:0
    ds_read_b64_tr_b16 v[30:31], v11 offset:1024
    v_mfma_f32_16x16x32_bf16 v[88:91], v[56:59], v[52:55], v[88:91]
    v_mfma_f32_16x16x32_bf16 v[92:95], v[60:63], v[52:55], v[92:95]
    s_waitcnt lgkmcnt(0)
    v_mfma_f32_16x16x32_bf16 v[64:67], v[32:35], v[16:19], v[64:67]
    v_mfma_f32_16x16x32_bf16 v[68:71], v[36:39], v[16:19], v[68:71]
    s_waitcnt vmcnt(6)
    s_barrier
    s_add_u32 m0, s8, 0
    s_add_u32 s10, s9, s68
    buffer_load_dwordx4 v6, s[48:51], s10 offen lds
    s_add_u32 s68, s68, 86016
    s_cmp_ge_u32 s68, 1204224
    s_cselect_b32 s68, 0, s68
    ds_read_b128 v[56:59], v4 offset:16384
    ds_read_b128 v[60:63], v4 offset:18432
    v_mfma_f32_16x16x32_bf16 v[72:75], v[32:35], v[20:23], v[72:75]
    ds_read_b64_tr_b16 v[40:41], v8 offset:8192
    ds_read_b64_tr_b16 v[42:43], v8 offset:9216
    v_mfma_f32_16x16x32_bf16 v[76:79], v[36:39], v[20:23], v[76:79]
    ds_read_b64_tr_b16 v[44:45], v9 offset:8192
    ds_read_b64_tr_b16 v[46:47], v9 offset:9216
    v_mfma_f32_16x16x32_bf16 v[80:83], v[32:35], v[24:27], v[80:83]
    ds_read_b64_tr_b16 v[48:49], v10 offset:8192
    ds_read_b64_tr_b16 v[50:51], v10 offset:9216
    v_mfma_f32_16x16x32_bf16 v[84:87], v[36:39], v[24:27], v[84:87]
    ds_read_b64_tr_b16 v[52:53], v11 offset:8192
    ds_read_b64_tr_b16 v[54:55], v11 offset:9216
    v_mfma_f32_16x16x32_bf16 v[88:91], v[32:35], v[28:31], v[88:91]
    v_mfma_f32_16x16x32_bf16 v[92:95], v[36:39], v[28:31], v[92:95]
    s_waitcnt lgkmcnt(0)
    v_mfma_f32_16x16x32_bf16 v[64:67], v[56:59], v[40:43], v[64:67]
    v_mfma_f32_16x16x32_bf16 v[68:71], v[60:63], v[40:43], v[68:71]
    s_waitcnt vmcnt(4)
    s_barrier
    s_add_u32 m0, s8, 8192
    s_add_u32 s10, s9, s68
    buffer_load_dwordx4 v6, s[48:51], s10 offen lds
    s_add_u32 s68, s68, 86016
    s_cmp_ge_u32 s68, 1204224
    s_cselect_b32 s68, 0, s68
    ds_read_b128 v[32:35], v3 offset:32768
    ds_read_b128 v[36:39], v3 offset:34816
    v_mfma_f32_16x16x32_bf16 v[72:75], v[56:59], v[44:47], v[72:75]
    ds_read_b64_tr_b16 v[16:17], v8 offset:16384
    ds_read_b64_tr_b16 v[18:19], v8 offset:17408
    v_mfma_f32_16x16x32_bf16 v[76:79], v[60:63], v[44:47], v[76:79]
    ds_read_b64_tr_b16 v[20:21], v9 offset:16384
    ds_read_b64_tr_b16 v[22:23], v9 offset:17408
    v_mfma_f32_16x16x32_bf16 v[80:83], v[56:59], v[48:51], v[80:83]
    ds_read_b64_tr_b16 v[24:25], v10 offset:16384
    ds_read_b64_tr_b16 v[26:27], v10 offset:17408
    v_mfma_f32_16x16x32_bf16 v[84:87], v[60:63], v[48:51], v[84:87]
    ds_read_b64_tr_b16 v[28:29], v11 offset:16384
    ds_read_b64_tr_b16 v[30:31], v11 offset:17408
    v_mfma_f32_16x16x32_bf16 v[88:91], v[56:59], v[52:55], v[88:91]
    v_mfma_f32_16x16x32_bf16 v[92:95], v[60:63], v[52:55], v[92:95]
    s_waitcnt lgkmcnt(0)
    v_mfma_f32_16x16x32_bf16 v[64:67], v[32:35], v[16:19], v[64:67]
    v_mfma_f32_16x16x32_bf16 v[68:71], v[36:39], v[16:19], v[68:71]
    s_waitcnt vmcnt(4)
    s_barrier
    ds_read_b128 v[56:59], v4 offset:32768
    ds_read_b128 v[60:63], v4 offset:34816
    v_mfma_f32_16x16x32_bf16 v[72:75], v[32:35], v[20:23], v[72:75]
    ds_read_b64_tr_b16 v[40:41], v8 offset:24576
    ds_read_b64_tr_b16 v[42:43], v8 offset:25600
    v_mfma_f32_16x16x32_bf16 v[76:79], v[36:39], v[20:23], v[76:79]
    ds_read_b64_tr_b16 v[44:45], v9 offset:24576
    ds_read_b64_tr_b16 v[46:47], v9 offset:25600
    v_mfma_f32_16x16x32_bf16 v[80:83], v[32:35], v[24:27], v[80:83]
    ds_read_b64_tr_b16 v[48:49], v10 offset:24576
    ds_read_b64_tr_b16 v[50:51], v10 offset:25600
    v_mfma_f32_16x16x32_bf16 v[84:87], v[36:39], v[24:27], v[84:87]
    ds_read_b64_tr_b16 v[52:53], v11 offset:24576
    ds_read_b64_tr_b16 v[54:55], v11 offset:25600
    v_mfma_f32_16x16x32_bf16 v[88:91], v[32:35], v[28:31], v[88:91]
    v_mfma_f32_16x16x32_bf16 v[92:95], v[36:39], v[28:31], v[92:95]
    s_cmp_lg_u32 s5, 7
    s_cbranch_scc1 snap_1
    v_mov_b32 v0, 32
    buffer_load_dword v5, v0, s[64:67], 0 offen
snap_1:
    s_waitcnt lgkmcnt(0)
    v_mfma_f32_16x16x32_bf16 v[64:67], v[56:59], v[40:43], v[64:67]
    v_mfma_f32_16x16x32_bf16 v[68:71], v[60:63], v[40:43], v[68:71]
    s_waitcnt vmcnt(1)
    s_barrier
    ds_read_b128 v[32:35], v3 offset:0
    ds_read_b128 v[36:39], v3 offset:2048
    v_mfma_f32_16x16x32_bf16 v[72:75], v[56:59], v[44:47], v[72:75]
    ds_read_b64_tr_b16 v[16:17], v8 offset:0
    ds_read_b64_tr_b16 v[18:19], v8 offset:1024
    v_mfma_f32_16x16x32_bf16 v[76:79], v[60:63], v[44:47], v[76:79]
    ds_read_b64_tr_b16 v[20:21], v9 offset:0
    ds_read_b64_tr_b16 v[22:23], v9 offset:1024
    v_mfma_f32_16x16x32_bf16 v[80:83], v[56:59], v[48:51], v[80:83]
    ds_read_b64_tr_b16 v[24:25], v10 offset:0
    ds_read_b64_tr_b16 v[26:27], v10 offset:1024
    v_mfma_f32_16x16x32_bf16 v[84:87], v[60:63], v[48:51], v[84:87]
    ds_read_b64_tr_b16 v[28:29], v11 offset:0
    ds_read_b64_tr_b16 v[30:31], v11 offset:1024
    v_mfma_f32_16x16x32_bf16 v[88:91], v[56:59], v[52:55], v[88:91]
    v_mfma_f32_16x16x32_bf16 v[92:95], v[60:63], v[52:55], v[92:95]
    s_waitcnt lgkmcnt(0)
    v_mfma_f32_16x16x32_bf16 v[64:67], v[32:35], v[16:19], v[64:67]
    v_mfma_f32_16x16x32_bf16 v[68:71], v[36:39], v[16:19], v[68:71]
    s_waitcnt vmcnt(0)
    s_barrier
    ds_read_b128 v[56:59], v4 offset:0
    ds_read_b128 v[60:63], v4 offset:2048
    v_mfma_f32_16x16x32_bf16 v[72:75], v[32:35], v[20:23], v[72:75]
    ds_read_b64_tr_b16 v[40:41], v8 offset:8192
    ds_read_b64_tr_b16 v[42:43], v8 offset:9216
    v_mfma_f32_16x16x32_bf16 v[76:79], v[36:39], v[20:23], v[76:79]
    ds_read_b64_tr_b16 v[44:45], v9 offset:8192
    ds_read_b64_tr_b16 v[46:47], v9 offset:9216
    v_mfma_f32_16x16x32_bf16 v[80:83], v[32:35], v[24:27], v[80:83]
    ds_read_b64_tr_b16 v[48:49], v10 offset:8192
    ds_read_b64_tr_b16 v[50:51], v10 offset:9216
    v_mfma_f32_16x16x32_bf16 v[84:87], v[36:39], v[24:27], v[84:87]
    ds_read_b64_tr_b16 v[52:53], v11 offset:8192
    ds_read_b64_tr_b16 v[54:55], v11 offset:9216
    v_mfma_f32_16x16x32_bf16 v[88:91], v[32:35], v[28:31], v[88:91]
    v_mfma_f32_16x16x32_bf16 v[92:95], v[36:39], v[28:31], v[92:95]
    s_waitcnt lgkmcnt(0)
    v_mfma_f32_16x16x32_bf16 v[64:67], v[56:59], v[40:43], v[64:67]
    v_mfma_f32_16x16x32_bf16 v[68:71], v[60:63], v[40:43], v[68:71]
    v_mfma_f32_16x16x32_bf16 v[72:75], v[56:59], v[44:47], v[72:75]
    v_mfma_f32_16x16x32_bf16 v[76:79], v[60:63], v[44:47], v[76:79]
    v_mfma_f32_16x16x32_bf16 v[80:83], v[56:59], v[48:51], v[80:83]
    v_mfma_f32_16x16x32_bf16 v[84:87], v[60:63], v[48:51], v[84:87]
    v_mfma_f32_16x16x32_bf16 v[88:91], v[56:59], v[52:55], v[88:91]
    v_mfma_f32_16x16x32_bf16 v[92:95], v[60:63], v[52:55], v[92:95]
    v_readfirstlane_b32 s42, v12
    v_readfirstlane_b32 s43, v13
    s_waitcnt vmcnt(0)
    s_barrier
    s_sub_u32 s10, s4, 28
    s_cmp_ge_u32 s10, 16
    s_cselect_b32 s6, 2, 0
    s_sub_u32 s10, s10, s6
    s_mul_i32 s6, s10, 21846
    s_lshr_b32 s6, s6, 16
    s_mul_i32 s7, s6, 3
    s_sub_u32 s7, s10, s7
    s_and_b32 s8, s3, 1
    s_lshl_b32 s8, s8, 2
    s_add_u32 s9, s7, s8
    s_sub_u32 s7, s10, 24
    s_add_u32 s7, s7, s8
    s_cmp_ge_u32 s10, 24
    s_cselect_b32 s9, 3, s9
    s_cselect_b32 s6, s7, s6
    s_lshr_b32 s7, s3, 1
    s_lshl_b32 s7, s7, 3
    s_add_u32 s8, s6, s7
    s_mov_b32 s68, s20
    s_mov_b32 s69, s21
    s_mov_b32 s70, 0x62000
    s_mov_b32 s71, 0x00020000
    v_lshrrev_b32 v0, 3, v7
    v_bfe_u32 v14, v7, 1, 2
    v_lshrrev_b32 v13, 2, v0
    v_xor_b32 v14, v14, v13
    s_and_b32 s6, s5, 1
    s_lshl_b32 s6, s6, 1
    v_xor_b32 v14, s6, v14
    v_and_b32 v13, 1, v7
    v_lshl_or_b32 v14, v14, 1, v13
    s_lshl_b32 s6, s5, 3
    v_add_u32 v0, s6, v0
    v_mul_u32_u24 v0, 896, v0
    v_lshl_add_u32 v14, v14, 4, v0
    s_lshl_b32 s6, s5, 10
    s_add_u32 m0, s6, 0
    s_lshl_b32 s6, s9, 7
    s_add_u32 s6, s6, 0
    buffer_load_dwordx4 v14, s[68:71], s6 offen lds
    s_lshl_b32 s6, s5, 10
    s_add_u32 m0, s6, 8192
    s_lshl_b32 s6, s9, 7
    s_add_u32 s6, s6, 57344
    buffer_load_dwordx4 v14, s[68:71], s6 offen lds
    s_lshl_b32 s6, s5, 10
    s_add_u32 m0, s6, 16384
    s_lshl_b32 s6, s9, 7
    s_add_u32 s6, s6, 114688
    buffer_load_dwordx4 v14, s[68:71], s6 offen lds
    s_lshl_b32 s6, s5, 10
    s_add_u32 m0, s6, 24576
    s_lshl_b32 s6, s9, 7
    s_add_u32 s6, s6, 172032
    buffer_load_dwordx4 v14, s[68:71], s6 offen lds
    s_lshl_b32 s6, s5, 10
    s_add_u32 m0, s6, 32768
    s_lshl_b32 s6, s9, 7
    s_add_u32 s6, s6, 229376
    buffer_load_dwordx4 v14, s[68:71], s6 offen lds
    s_lshl_b32 s6, s5, 10
    s_add_u32 m0, s6, 40960
    s_lshl_b32 s6, s9, 7
    s_add_u32 s6, s6, 286720
    buffer_load_dwordx4 v14, s[68:71], s6 offen lds
    v_pk_mul_f32 v[96:97], v[64:65], s[14:15]
    v_pk_mul_f32 v[98:99], v[66:67], s[14:15]
    v_pk_mul_f32 v[100:101], v[68:69], s[14:15]
    v_pk_mul_f32 v[102:103], v[70:71], s[14:15]
    v_pk_mul_f32 v[104:105], v[72:73], s[14:15]
    v_pk_mul_f32 v[106:107], v[74:75], s[14:15]
    v_pk_mul_f32 v[108:109], v[76:77], s[14:15]
    v_pk_mul_f32 v[110:111], v[78:79], s[14:15]
    s_mov_b32 s76, 0x358637bd
    s_mov_b32 s77, 0x358637bd
    v_exp_f32_e64 v96, v96 clamp
    v_max_f32 v64, 0, v64
    v_exp_f32_e64 v97, v97 clamp
    v_max_f32 v65, 0, v65
    v_exp_f32_e64 v98, v98 clamp
    v_max_f32 v66, 0, v66
    v_exp_f32_e64 v99, v99 clamp
    v_max_f32 v67, 0, v67
    v_exp_f32_e64 v100, v100 clamp
    v_max_f32 v68, 0, v68
    v_exp_f32_e64 v101, v101 clamp
    v_max_f32 v69, 0, v69
    v_exp_f32_e64 v102, v102 clamp
    v_max_f32 v70, 0, v70
    v_exp_f32_e64 v103, v103 clamp
    v_max_f32 v71, 0, v71
    v_exp_f32_e64 v104, v104 clamp
    v_max_f32 v72, 0, v72
    v_exp_f32_e64 v105, v105 clamp
    v_max_f32 v73, 0, v73
    v_exp_f32_e64 v106, v106 clamp
    v_max_f32 v74, 0, v74
    v_exp_f32_e64 v107, v107 clamp
    v_max_f32 v75, 0, v75
    v_exp_f32_e64 v108, v108 clamp
    v_max_f32 v76, 0, v76
    v_exp_f32_e64 v109, v109 clamp
    v_max_f32 v77, 0, v77
    v_exp_f32_e64 v110, v110 clamp
    v_max_f32 v78, 0, v78
    v_exp_f32_e64 v111, v111 clamp
    v_max_f32 v79, 0, v79
    v_pk_add_f32 v[64:65], v[64:65], v[96:97]
    v_pk_add_f32 v[66:67], v[66:67], v[98:99]
    v_pk_add_f32 v[68:69], v[68:69], v[100:101]
    v_pk_add_f32 v[70:71], v[70:71], v[102:103]
    v_pk_add_f32 v[72:73], v[72:73], v[104:105]
    v_pk_add_f32 v[74:75], v[74:75], v[106:107]
    v_pk_add_f32 v[76:77], v[76:77], v[108:109]
    v_pk_add_f32 v[78:79], v[78:79], v[110:111]
    v_pk_add_f32 v[64:65], v[64:65], s[76:77]
    v_pk_add_f32 v[66:67], v[66:67], s[76:77]
    v_pk_add_f32 v[68:69], v[68:69], s[76:77]
    v_pk_add_f32 v[70:71], v[70:71], s[76:77]
    v_pk_add_f32 v[72:73], v[72:73], s[76:77]
    v_pk_add_f32 v[74:75], v[74:75], s[76:77]
    v_pk_add_f32 v[76:77], v[76:77], s[76:77]
    v_pk_add_f32 v[78:79], v[78:79], s[76:77]
    v_cvt_pk_bf16_f32 v112, v64, v65
    v_cvt_pk_bf16_f32 v113, v66, v67
    v_cvt_pk_bf16_f32 v114, v68, v69
    v_cvt_pk_bf16_f32 v115, v70, v71
    v_cvt_pk_bf16_f32 v116, v72, v73
    v_cvt_pk_bf16_f32 v117, v74, v75
    v_cvt_pk_bf16_f32 v118, v76, v77
    v_cvt_pk_bf16_f32 v119, v78, v79
    v_cvt_pk_bf16_f32 v120, v80, v81
    v_cvt_pk_bf16_f32 v121, v82, v83
    v_cvt_pk_bf16_f32 v122, v84, v85
    v_cvt_pk_bf16_f32 v123, v86, v87
    v_cvt_pk_bf16_f32 v124, v88, v89
    v_cvt_pk_bf16_f32 v125, v90, v91
    v_cvt_pk_bf16_f32 v126, v92, v93
    v_cvt_pk_bf16_f32 v127, v94, v95
    s_and_b32 s7, s5, 1
    s_cmp_eq_u32 s7, 1
    s_cselect_b32 s6, 0x000f000f, 0
    s_mov_b32 s7, s6
    s_mov_b64 exec, s[6:7]
    v_mov_b32 v112, 0
    v_mov_b32 v113, 0
    v_mov_b32 v114, 0
    v_mov_b32 v115, 0
    s_cselect_b32 s6, 0, 0xf000f000
    s_mov_b32 s7, s6
    s_mov_b64 exec, s[6:7]
    v_mov_b32 v116, 0
    v_mov_b32 v117, 0
    v_mov_b32 v118, 0
    v_mov_b32 v119, 0
    s_mov_b32 s6, 0xe000e000
    s_mov_b32 s7, s6
    s_mov_b64 exec, s[6:7]
    v_mov_b32 v124, 0
    v_mov_b32 v125, 0
    v_mov_b32 v126, 0
    v_mov_b32 v127, 0
    s_mov_b32 s6, 0x10001000
    s_mov_b32 s7, s6
    s_mov_b64 exec, s[6:7]
    s_mov_b32 s6, 0x3f803f80
    v_mov_b32 v124, s6
    v_mov_b32 v125, s6
    v_mov_b32 v126, s6
    v_mov_b32 v127, s6
    s_mov_b64 exec, -1
    v_mfma_f32_16x16x32_bf16 v[16:19], v[120:123], v[112:115], 0
    v_mfma_f32_16x16x32_bf16 v[20:23], v[120:123], v[116:119], 0
    v_mfma_f32_16x16x32_bf16 v[24:27], v[124:127], v[112:115], 0
    v_mfma_f32_16x16x32_bf16 v[28:31], v[124:127], v[116:119], 0
    s_lshl_b32 s6, s5, 12
    s_add_u32 s6, s6, 49152
    v_lshl_add_u32 v0, v7, 4, s6
    v_bfe_u32 v1, v7, 2, 2
    v_lshrrev_b32 v2, 4, v7
    s_and_b32 s6, s5, 2
    s_lshl_b32 s6, s6, 1
    v_add_u32 v1, s6, v1
    v_lshl_add_u32 v2, v1, 2, v2
    v_cmp_eq_u32 vcc, 7, v1
    v_mov_b32 v3, 28
    s_nop 0
    v_cndmask_b32 v2, v2, v3, vcc
    ds_write_b128 v0, v[16:19] offset:0
    ds_write_b128 v0, v[20:23] offset:1024
    ds_write_b128 v0, v[24:27] offset:2048
    ds_write_b128 v0, v[28:31] offset:3072
    v_lshrrev_b32 v1, 4, v2
    v_lshlrev_b32 v1, 11, v1
    v_bfe_u32 v3, v2, 2, 2
    v_lshl_add_u32 v1, v3, 8, v1
    v_and_b32 v3, 3, v2
    v_lshl_add_u32 v1, v3, 2, v1
    v_and_b32 v3, 3, v7
    v_lshl_add_u32 v1, v3, 4, v1
    s_lshr_b32 s6, s5, 2
    s_lshl_b32 s6, s6, 12
    s_and_b32 s7, s5, 1
    s_lshl_b32 s7, s7, 6
    s_add_u32 s6, s6, s7
    s_add_u32 s6, s6, 49152
    v_add_u32 v1, s6, v1
    s_cmp_lg_u32 s5, 7
    s_cbranch_scc1 zok_2
    s_mov_b32 s6, 0
    v_mov_b32 v4, 32
zp_3:
    v_readfirstlane_b32 s7, v5
    s_nop 0
    s_cmp_ge_u32 s7, 16
    s_cbranch_scc1 zok_2
    s_sleep 8
    buffer_load_dword v5, v4, s[64:67], 0 offen sc1
    s_add_u32 s6, s6, 1
    s_waitcnt vmcnt(0)
    s_cmp_lt_u32 s6, 0x10000
    s_cbranch_scc1 zp_3
zok_2:
    s_waitcnt lgkmcnt(0)
    s_barrier
    ds_read_b32 v40, v1 offset:0
    ds_read_b32 v41, v1 offset:128
    ds_read_b32 v42, v1 offset:1024
    ds_read_b32 v43, v1 offset:1152
    ds_read_b32 v44, v1 offset:8192
    ds_read_b32 v45, v1 offset:8320
    ds_read_b32 v46, v1 offset:9216
    ds_read_b32 v47, v1 offset:9344
    ds_read_b32 v48, v1 offset:16384
    ds_read_b32 v49, v1 offset:16512
    ds_read_b32 v50, v1 offset:17408
    ds_read_b32 v51, v1 offset:17536
    ds_read_b32 v52, v1 offset:24576
    ds_read_b32 v53, v1 offset:24704
    ds_read_b32 v54, v1 offset:25600
    s_waitcnt lgkmcnt(12)
    ds_read_b32 v55, v1 offset:25728
    s_lshl_b32 s6, s12, 3
    s_add_u32 s6, s6, s5
    s_lshl_b32 s6, s6, 10
    v_lshlrev_b32 v3, 2, v7
    s_waitcnt lgkmcnt(0)
    v_pk_add_f32 v[40:41], v[40:41], v[44:45]
    v_pk_add_f32 v[48:49], v[48:49], v[52:53]
    v_pk_add_f32 v[42:43], v[42:43], v[46:47]
    v_pk_add_f32 v[50:51], v[50:51], v[54:55]
    v_pk_add_f32 v[40:41], v[40:41], v[48:49]
    v_pk_add_f32 v[42:43], v[42:43], v[50:51]
    buffer_atomic_add_f32 v40, v3, s[56:59], s6 offen offset:0
    buffer_atomic_add_f32 v41, v3, s[56:59], s6 offen offset:256
    buffer_atomic_add_f32 v42, v3, s[56:59], s6 offen offset:512
    buffer_atomic_add_f32 v43, v3, s[56:59], s6 offen offset:768
    s_waitcnt vmcnt(0)
    s_barrier
    s_cmp_lg_u32 s5, 7
    s_cbranch_scc1 arr_4
    s_lshl_b32 s6, s12, 8
    s_add_u32 s6, s6, 65536
    v_mov_b32 v1, s6
    v_mov_b32 v2, 1
    s_mov_b64 exec, 1
    buffer_atomic_add v2, v1, s[56:59], 0 offen sc0 sc1
    s_mov_b64 exec, -1
    s_waitcnt vmcnt(0)
    v_readfirstlane_b32 s7, v2
    s_nop 0
    s_cmp_lg_u32 s7, 15
    s_cbranch_scc1 arr_4
    s_mov_b32 s6, 71680
    v_mov_b32 v1, s6
    v_mov_b32 v2, 1
    s_mov_b64 exec, 1
    buffer_atomic_add v2, v1, s[56:59], 0 offen sc0 sc1
    s_mov_b64 exec, -1
    s_waitcnt vmcnt(0)
    v_readfirstlane_b32 s7, v2
    s_nop 0
    s_cmp_lg_u32 s7, 23
    s_cbranch_scc1 arr_4
    v_lshlrev_b32 v1, 7, v7
    v_mov_b32 v2, 1
    s_mov_b32 s6, 28672
    buffer_atomic_add v2, v1, s[72:75], s6 offen sc1
    s_mov_b32 s6, 36864
    buffer_atomic_add v2, v1, s[72:75], s6 offen sc1
    s_mov_b32 s6, 45056
    buffer_atomic_add v2, v1, s[72:75], s6 offen sc1
    s_mov_b32 s6, 53248
    s_mov_b32 s10, -1
    s_mov_b32 s11, 0xffff
    s_mov_b64 exec, s[10:11]
    buffer_atomic_add v2, v1, s[72:75], s6 offen sc1
    s_mov_b64 exec, -1
arr_4:
    s_branch A2_entry
Q_entry:
    s_and_b32 s14, s3, 1
    s_sub_u32 s10, s4, 44
    s_mul_i32 s6, s10, 21846
    s_lshr_b32 s6, s6, 16
    s_mul_i32 s7, s6, 3
    s_sub_u32 s7, s10, s7
    s_lshl_b32 s15, s14, 2
    s_add_u32 s12, s7, s15
    s_lshl_b32 s15, s14, 1
    s_add_u32 s15, s15, s7
    s_cmp_ge_u32 s10, 12
    s_cselect_b32 s12, 3, s12
    s_cselect_b32 s6, s15, s6
    s_lshl_b32 s9, s12, 7
    s_lshr_b32 s11, s3, 1
    s_lshl_b32 s11, s11, 2
    s_add_u32 s11, s11, s6
    s_lshl_b32 s6, s11, 3
    s_add_u32 s6, s6, s5
    s_mul_i32 s76, s6, 14336
    s_add_u32 s77, s76, 7168
    s_lshl_b32 s100, s2, 7
    s_and_b32 s6, s11, 3
    s_lshl_b32 s6, s6, 1
    s_and_b32 s7, s12, 3
    s_add_u32 s6, s6, s7
    s_add_u32 s6, s6, 4
    s_cmp_ge_u32 s6, 7
    s_cselect_b32 s7, 7, 0
    s_sub_u32 s6, s6, s7
    s_lshl_b32 s69, s6, 7
    s_mul_i32 s68, s6, 172032
    v_and_b32 v24, 15, v7
    v_lshrrev_b32 v25, 4, v7
    v_lshrrev_b32 v16, 3, v7
    v_and_b32 v17, 7, v7
    v_xor_b32 v17, v17, v16
    v_mul_u32_u24 v18, 896, v16
    v_lshl_add_u32 v1, v17, 4, v18
    s_lshl_b32 s78, s5, 11
    s_add_u32 s78, s78, 32768
    s_and_b32 s6, s5, 2
    s_lshl_b32 s6, s6, 1
    v_or_b32 v20, s6, v25
    v_lshrrev_b32 v21, 1, v24
    v_xor_b32 v21, v21, v20
    v_and_b32 v22, 1, v24
    v_lshl_or_b32 v21, v21, 1, v22
    v_lshrrev_b32 v22, 3, v21
    v_and_b32 v21, 7, v21
    s_lshl_b32 s6, s5, 2
    v_add_u32 v23, s6, v25
    v_mul_u32_u24 v23, 2688, v23
    v_mul_u32_u24 v22, 86016, v22
    v_lshl_add_u32 v23, v21, 4, v23
    v_add_u32 v6, v23, v22
    s_lshl_b32 s8, s5, 10
    v_mov_b32 v0, s100
    s_waitcnt lgkmcnt(0)
    s_mov_b32 s44, s16
    s_mov_b32 s45, s17
    s_mov_b32 s46, 0x1c0000
    s_mov_b32 s47, 0x00020000
    s_mov_b32 s48, s18
    s_mov_b32 s49, s19
    s_mov_b32 s50, 0x126000
    s_mov_b32 s51, 0x00020000
    s_add_u32 s56, s40, 0x400000
    s_addc_u32 s57, s41, 0
    s_mov_b32 s58, 0x12000
    s_mov_b32 s59, 0x00020000
    s_add_u32 m0, s78, 0
    s_add_u32 s10, s76, s69
    buffer_load_dwordx4 v1, s[44:47], s10 offen lds
    s_add_u32 m0, s78, 1024
    s_add_u32 s10, s77, s69
    buffer_load_dwordx4 v1, s[44:47], s10 offen lds
    s_add_u32 s69, s69, 128
    s_cmp_ge_u32 s69, 896
    s_cselect_b32 s69, 0, s69
    s_add_u32 m0, s8, 0
    s_add_u32 s10, s9, s68
    buffer_load_dwordx4 v6, s[48:51], s10 offen lds
    s_add_u32 s68, s68, 172032
    s_cmp_ge_u32 s68, 1204224
    s_cselect_b32 s68, 0, s68
    s_barrier
    s_add_u32 m0, s78, 16384
    s_add_u32 s10, s76, s69
    buffer_load_dwordx4 v1, s[44:47], s10 offen lds
    s_add_u32 m0, s78, 17408
    s_add_u32 s10, s77, s69
    buffer_load_dwordx4 v1, s[44:47], s10 offen lds
    s_add_u32 s69, s69, 128
    s_cmp_ge_u32 s69, 896
    s_cselect_b32 s69, 0, s69
    s_add_u32 m0, s8, 8192
    s_add_u32 s10, s9, s68
    buffer_load_dwordx4 v6, s[48:51], s10 offen lds
    s_add_u32 s68, s68, 172032
    s_cmp_ge_u32 s68, 1204224
    s_cselect_b32 s68, 0, s68
    s_barrier
    s_add_u32 m0, s78, 32768
    s_add_u32 s10, s76, s69
    buffer_load_dwordx4 v1, s[44:47], s10 offen lds
    s_add_u32 m0, s78, 33792
    s_add_u32 s10, s77, s69
    buffer_load_dwordx4 v1, s[44:47], s10 offen lds
    s_add_u32 s69, s69, 128
    s_cmp_ge_u32 s69, 896
    s_cselect_b32 s69, 0, s69
    s_add_u32 m0, s8, 16384
    s_add_u32 s10, s9, s68
    buffer_load_dwordx4 v6, s[48:51], s10 offen lds
    s_add_u32 s68, s68, 172032
    s_cmp_ge_u32 s68, 1204224
    s_cselect_b32 s68, 0, s68
    s_add_u32 m0, s8, 24576
    s_add_u32 s10, s9, s68
    buffer_load_dwordx4 v6, s[48:51], s10 offen lds
    s_add_u32 s68, s68, 172032
    s_cmp_ge_u32 s68, 1204224
    s_cselect_b32 s68, 0, s68
    s_add_u32 s72, s40, 0x480000
    s_addc_u32 s73, s41, 0
    s_mov_b32 s74, 0x20000
    s_mov_b32 s75, 0x00020000
    buffer_load_dwordx2 v[12:13], v0, s[72:75], 0 offen sc1
    s_mov_b32 s64, s38
    s_mov_b32 s65, s39
    s_mov_b32 s66, 0x100
    s_mov_b32 s67, 0x00020000
    s_mov_b32 s52, s40
    s_mov_b32 s53, s41
    s_mov_b32 s54, 0x1c0000
    s_mov_b32 s55, 0x00020000
    s_lshr_b32 s6, s5, 1
    s_lshl_b32 s6, s6, 12
    s_add_u32 s6, s6, 32768
    v_and_b32 v16, 7, v24
    v_xor_b32 v16, v16, v25
    v_lshlrev_b32 v16, 4, v16
    v_lshl_add_u32 v16, v24, 7, v16
    v_xor_b32 v17, 64, v16
    v_add_u32 v3, s6, v16
    v_add_u32 v4, s6, v17
    v_bfe_u32 v16, v7, 2, 2
    v_and_b32 v17, 3, v7
    v_and_b32 v18, 1, v25
    v_lshl_or_b32 v18, v18, 2, v16
    v_lshl_add_u32 v19, v25, 3, v16
    v_lshlrev_b32 v19, 8, v19
    s_and_b32 s7, s5, 1
    s_lshl_b32 s6, s7, 6
    s_add_u32 s6, s6, 0
    v_lshlrev_b32 v20, 3, v17
    v_add_u32 v20, s6, v20
    v_lshrrev_b32 v21, 5, v20
    v_xor_b32 v21, v21, v18
    v_and_b32 v20, 31, v20
    v_lshl_or_b32 v20, v21, 5, v20
    v_add_u32 v8, v20, v19
    s_lshl_b32 s6, s7, 6
    s_add_u32 s6, s6, 32
    v_lshlrev_b32 v20, 3, v17
    v_add_u32 v20, s6, v20
    v_lshrrev_b32 v21, 5, v20
    v_xor_b32 v21, v21, v18
    v_and_b32 v20, 31, v20
    v_lshl_or_b32 v20, v21, 5, v20
    v_add_u32 v9, v20, v19
    s_lshl_b32 s6, s7, 6
    s_add_u32 s6, s6, 128
    v_lshlrev_b32 v20, 3, v17
    v_add_u32 v20, s6, v20
    v_lshrrev_b32 v21, 5, v20
    v_xor_b32 v21, v21, v18
    v_and_b32 v20, 31, v20
    v_lshl_or_b32 v20, v21, 5, v20
    v_add_u32 v10, v20, v19
    s_lshl_b32 s6, s7, 6
    s_add_u32 s6, s6, 160
    v_lshlrev_b32 v20, 3, v17
    v_add_u32 v20, s6, v20
    v_lshrrev_b32 v21, 5, v20
    v_xor_b32 v21, v21, v18
    v_and_b32 v20, 31, v20
    v_lshl_or_b32 v20, v21, 5, v20
    v_add_u32 v11, v20, v19
    s_mov_b32 s14, 0x3fb8aa3b
    s_mov_b32 s15, 0x3fb8aa3b
    s_mov_b32 s13, 0x358637bd
    s_waitcnt vmcnt(8)
    s_barrier
    ds_read_b128 v[32:35], v3 offset:0
    ds_read_b128 v[36:39], v4 offset:0
    ds_read_b128 v[40:43], v3 offset:2048
    ds_read_b128 v[44:47], v4 offset:2048
    ds_read_b64_tr_b16 v[16:17], v8 offset:0
    ds_read_b64_tr_b16 v[18:19], v8 offset:1024
    ds_read_b64_tr_b16 v[20:21], v9 offset:0
    ds_read_b64_tr_b16 v[22:23], v9 offset:1024
    ds_read_b64_tr_b16 v[24:25], v10 offset:0
    ds_read_b64_tr_b16 v[26:27], v10 offset:1024
    ds_read_b64_tr_b16 v[28:29], v11 offset:0
    ds_read_b64_tr_b16 v[30:31], v11 offset:1024
    s_waitcnt lgkmcnt(0)
    v_mfma_f32_16x16x32_bf16 v[80:83], v[16:19], v[32:35], 0
    v_mfma_f32_16x16x32_bf16 v[88:91], v[16:19], v[40:43], 0
    s_waitcnt vmcnt(5)
    s_barrier
    s_add_u32 m0, s8, 0
    s_add_u32 s10, s9, s68
    buffer_load_dwordx4 v6, s[48:51], s10 offen lds
    s_add_u32 s68, s68, 172032
    s_cmp_ge_u32 s68, 1204224
    s_cselect_b32 s68, 0, s68
    s_add_u32 m0, s78, 0
    s_add_u32 s10, s76, s69
    buffer_load_dwordx4 v1, s[44:47], s10 offen lds
    s_add_u32 m0, s78, 1024
    s_add_u32 s10, s77, s69
    buffer_load_dwordx4 v1, s[44:47], s10 offen lds
    s_add_u32 s69, s69, 128
    s_cmp_ge_u32 s69, 896
    s_cselect_b32 s69, 0, s69
    ds_read_b128 v[64:67], v3 offset:16384
    ds_read_b128 v[68:71], v4 offset:16384
    v_mfma_f32_16x16x32_bf16 v[84:87], v[20:23], v[32:35], 0
    ds_read_b128 v[72:75], v3 offset:18432
    ds_read_b128 v[76:79], v4 offset:18432
    v_mfma_f32_16x16x32_bf16 v[92:95], v[20:23], v[40:43], 0
    ds_read_b64_tr_b16 v[48:49], v8 offset:8192
    ds_read_b64_tr_b16 v[50:51], v8 offset:9216
    v_mfma_f32_16x16x32_bf16 v[80:83], v[24:27], v[36:39], v[80:83]
    ds_read_b64_tr_b16 v[52:53], v9 offset:8192
    ds_read_b64_tr_b16 v[54:55], v9 offset:9216
    v_mfma_f32_16x16x32_bf16 v[88:91], v[24:27], v[44:47], v[88:91]
    ds_read_b64_tr_b16 v[56:57], v10 offset:8192
    ds_read_b64_tr_b16 v[58:59], v10 offset:9216
    v_mfma_f32_16x16x32_bf16 v[84:87], v[28:31], v[36:39], v[84:87]
    ds_read_b64_tr_b16 v[60:61], v11 offset:8192
    ds_read_b64_tr_b16 v[62:63], v11 offset:9216
    v_mfma_f32_16x16x32_bf16 v[92:95], v[28:31], v[44:47], v[92:95]
    s_waitcnt lgkmcnt(0)
    v_mfma_f32_16x16x32_bf16 v[80:83], v[48:51], v[64:67], v[80:83]
    v_mfma_f32_16x16x32_bf16 v[88:91], v[48:51], v[72:75], v[88:91]
    s_waitcnt vmcnt(5)
    s_barrier
    s_add_u32 m0, s8, 8192
    s_add_u32 s10, s9, s68
    buffer_load_dwordx4 v6, s[48:51], s10 offen lds
    s_add_u32 s68, s68, 172032
    s_cmp_ge_u32 s68, 1204224
    s_cselect_b32 s68, 0, s68
    s_add_u32 m0, s78, 16384
    s_add_u32 s10, s76, s69
    buffer_load_dwordx4 v1, s[44:47], s10 offen lds
    s_add_u32 m0, s78, 17408
    s_add_u32 s10, s77, s69
    buffer_load_dwordx4 v1, s[44:47], s10 offen lds
    s_add_u32 s69, s69, 128
    s_cmp_ge_u32 s69, 896
    s_cselect_b32 s69, 0, s69
    ds_read_b128 v[32:35], v3 offset:32768
    ds_read_b128 v[36:39], v4 offset:32768
    v_mfma_f32_16x16x32_bf16 v[84:87], v[52:55], v[64:67], v[84:87]
    ds_read_b128 v[40:43], v3 offset:34816
    ds_read_b128 v[44:47], v4 offset:34816
    v_mfma_f32_16x16x32_bf16 v[92:95], v[52:55], v[72:75], v[92:95]
    ds_read_b64_tr_b16 v[16:17], v8 offset:16384
    ds_read_b64_tr_b16 v[18:19], v8 offset:17408
    v_mfma_f32_16x16x32_bf16 v[80:83], v[56:59], v[68:71], v[80:83]
    ds_read_b64_tr_b16 v[20:21], v9 offset:16384
    ds_read_b64_tr_b16 v[22:23], v9 offset:17408
    v_mfma_f32_16x16x32_bf16 v[88:91], v[56:59], v[76:79], v[88:91]
    ds_read_b64_tr_b16 v[24:25], v10 offset:16384
    ds_read_b64_tr_b16 v[26:27], v10 offset:17408
    v_mfma_f32_16x16x32_bf16 v[84:87], v[60:63], v[68:71], v[84:87]
    ds_read_b64_tr_b16 v[28:29], v11 offset:16384
    ds_read_b64_tr_b16 v[30:31], v11 offset:17408
    v_mfma_f32_16x16x32_bf16 v[92:95], v[60:63], v[76:79], v[92:95]
    s_waitcnt lgkmcnt(0)
    v_mfma_f32_16x16x32_bf16 v[80:83], v[16:19], v[32:35], v[80:83]
    v_mfma_f32_16x16x32_bf16 v[88:91], v[16:19], v[40:43], v[88:91]
    s_waitcnt vmcnt(3)
    s_barrier
    s_add_u32 m0, s8, 16384
    s_add_u32 s10, s9, s68
    buffer_load_dwordx4 v6, s[48:51], s10 offen lds
    s_add_u32 s68, s68, 172032
    s_cmp_ge_u32 s68, 1204224
    s_cselect_b32 s68, 0, s68
    s_add_u32 m0, s78, 32768
    s_add_u32 s10, s76, s69
    buffer_load_dwordx4 v1, s[44:47], s10 offen lds
    s_add_u32 m0, s78, 33792
    s_add_u32 s10, s77, s69
    buffer_load_dwordx4 v1, s[44:47], s10 offen lds
    s_add_u32 s69, s69, 128
    s_cmp_ge_u32 s69, 896
    s_cselect_b32 s69, 0, s69
    ds_read_b128 v[64:67], v3 offset:0
    ds_read_b128 v[68:71], v4 offset:0
    v_mfma_f32_16x16x32_bf16 v[84:87], v[20:23], v[32:35], v[84:87]
    ds_read_b128 v[72:75], v3 offset:2048
    ds_read_b128 v[76:79], v4 offset:2048
    v_mfma_f32_16x16x32_bf16 v[92:95], v[20:23], v[40:43], v[92:95]
    ds_read_b64_tr_b16 v[48:49], v8 offset:24576
    ds_read_b64_tr_b16 v[50:51], v8 offset:25600
    v_mfma_f32_16x16x32_bf16 v[80:83], v[24:27], v[36:39], v[80:83]
    ds_read_b64_tr_b16 v[52:53], v9 offset:24576
    ds_read_b64_tr_b16 v[54:55], v9 offset:25600
    v_mfma_f32_16x16x32_bf16 v[88:91], v[24:27], v[44:47], v[88:91]
    ds_read_b64_tr_b16 v[56:57], v10 offset:24576
    ds_read_b64_tr_b16 v[58:59], v10 offset:25600
    v_mfma_f32_16x16x32_bf16 v[84:87], v[28:31], v[36:39], v[84:87]
    ds_read_b64_tr_b16 v[60:61], v11 offset:24576
    ds_read_b64_tr_b16 v[62:63], v11 offset:25600
    v_mfma_f32_16x16x32_bf16 v[92:95], v[28:31], v[44:47], v[92:95]
    s_waitcnt lgkmcnt(0)
    v_mfma_f32_16x16x32_bf16 v[80:83], v[48:51], v[64:67], v[80:83]
    v_mfma_f32_16x16x32_bf16 v[88:91], v[48:51], v[72:75], v[88:91]
    s_waitcnt vmcnt(3)
    s_barrier
    s_add_u32 m0, s78, 0
    s_add_u32 s10, s76, s69
    buffer_load_dwordx4 v1, s[44:47], s10 offen lds
    s_add_u32 m0, s78, 1024
    s_add_u32 s10, s77, s69
    buffer_load_dwordx4 v1, s[44:47], s10 offen lds
    s_add_u32 s69, s69, 128
    s_cmp_ge_u32 s69, 896
    s_cselect_b32 s69, 0, s69
    ds_read_b128 v[32:35], v3 offset:16384
    ds_read_b128 v[36:39], v4 offset:16384
    v_mfma_f32_16x16x32_bf16 v[84:87], v[52:55], v[64:67], v[84:87]
    ds_read_b128 v[40:43], v3 offset:18432
    ds_read_b128 v[44:47], v4 offset:18432
    v_mfma_f32_16x16x32_bf16 v[92:95], v[52:55], v[72:75], v[92:95]
    ds_read_b64_tr_b16 v[16:17], v8 offset:0
    ds_read_b64_tr_b16 v[18:19], v8 offset:1024
    v_mfma_f32_16x16x32_bf16 v[80:83], v[56:59], v[68:71], v[80:83]
    ds_read_b64_tr_b16 v[20:21], v9 offset:0
    ds_read_b64_tr_b16 v[22:23], v9 offset:1024
    v_mfma_f32_16x16x32_bf16 v[88:91], v[56:59], v[76:79], v[88:91]
    ds_read_b64_tr_b16 v[24:25], v10 offset:0
    ds_read_b64_tr_b16 v[26:27], v10 offset:1024
    v_mfma_f32_16x16x32_bf16 v[84:87], v[60:63], v[68:71], v[84:87]
    ds_read_b64_tr_b16 v[28:29], v11 offset:0
    ds_read_b64_tr_b16 v[30:31], v11 offset:1024
    v_mfma_f32_16x16x32_bf16 v[92:95], v[60:63], v[76:79], v[92:95]
    s_waitcnt lgkmcnt(0)
    v_mfma_f32_16x16x32_bf16 v[80:83], v[16:19], v[32:35], v[80:83]
    v_mfma_f32_16x16x32_bf16 v[88:91], v[16:19], v[40:43], v[88:91]
    s_waitcnt vmcnt(2)
    s_barrier
    ds_read_b128 v[64:67], v3 offset:32768
    ds_read_b128 v[68:71], v4 offset:32768
    v_mfma_f32_16x16x32_bf16 v[84:87], v[20:23], v[32:35], v[84:87]
    ds_read_b128 v[72:75], v3 offset:34816
    ds_read_b128 v[76:79], v4 offset:34816
    v_mfma_f32_16x16x32_bf16 v[92:95], v[20:23], v[40:43], v[92:95]
    ds_read_b64_tr_b16 v[48:49], v8 offset:8192
    ds_read_b64_tr_b16 v[50:51], v8 offset:9216
    v_mfma_f32_16x16x32_bf16 v[80:83], v[24:27], v[36:39], v[80:83]
    ds_read_b64_tr_b16 v[52:53], v9 offset:8192
    ds_read_b64_tr_b16 v[54:55], v9 offset:9216
    v_mfma_f32_16x16x32_bf16 v[88:91], v[24:27], v[44:47], v[88:91]
    ds_read_b64_tr_b16 v[56:57], v10 offset:8192
    ds_read_b64_tr_b16 v[58:59], v10 offset:9216
    v_mfma_f32_16x16x32_bf16 v[84:87], v[28:31], v[36:39], v[84:87]
    ds_read_b64_tr_b16 v[60:61], v11 offset:8192
    ds_read_b64_tr_b16 v[62:63], v11 offset:9216
    v_mfma_f32_16x16x32_bf16 v[92:95], v[28:31], v[44:47], v[92:95]
    s_cmp_lg_u32 s5, 7
    s_cbranch_scc1 snap_5
    v_mov_b32 v0, 32
    buffer_load_dword v5, v0, s[64:67], 0 offen
snap_5:
    s_waitcnt lgkmcnt(0)
    v_mfma_f32_16x16x32_bf16 v[80:83], v[48:51], v[64:67], v[80:83]
    v_mfma_f32_16x16x32_bf16 v[88:91], v[48:51], v[72:75], v[88:91]
    s_waitcnt vmcnt(0)
    s_barrier
    ds_read_b128 v[32:35], v3 offset:0
    ds_read_b128 v[36:39], v4 offset:0
    v_mfma_f32_16x16x32_bf16 v[84:87], v[52:55], v[64:67], v[84:87]
    ds_read_b128 v[40:43], v3 offset:2048
    ds_read_b128 v[44:47], v4 offset:2048
    v_mfma_f32_16x16x32_bf16 v[92:95], v[52:55], v[72:75], v[92:95]
    ds_read_b64_tr_b16 v[16:17], v8 offset:16384
    ds_read_b64_tr_b16 v[18:19], v8 offset:17408
    v_mfma_f32_16x16x32_bf16 v[80:83], v[56:59], v[68:71], v[80:83]
    ds_read_b64_tr_b16 v[20:21], v9 offset:16384
    ds_read_b64_tr_b16 v[22:23], v9 offset:17408
    v_mfma_f32_16x16x32_bf16 v[88:91], v[56:59], v[76:79], v[88:91]
    ds_read_b64_tr_b16 v[24:25], v10 offset:16384
    ds_read_b64_tr_b16 v[26:27], v10 offset:17408
    v_mfma_f32_16x16x32_bf16 v[84:87], v[60:63], v[68:71], v[84:87]
    ds_read_b64_tr_b16 v[28:29], v11 offset:16384
    ds_read_b64_tr_b16 v[30:31], v11 offset:17408
    v_mfma_f32_16x16x32_bf16 v[92:95], v[60:63], v[76:79], v[92:95]
    s_waitcnt lgkmcnt(0)
    v_mfma_f32_16x16x32_bf16 v[80:83], v[16:19], v[32:35], v[80:83]
    v_mfma_f32_16x16x32_bf16 v[88:91], v[16:19], v[40:43], v[88:91]
    v_mfma_f32_16x16x32_bf16 v[84:87], v[20:23], v[32:35], v[84:87]
    v_mfma_f32_16x16x32_bf16 v[92:95], v[20:23], v[40:43], v[92:95]
    v_mfma_f32_16x16x32_bf16 v[80:83], v[24:27], v[36:39], v[80:83]
    v_mfma_f32_16x16x32_bf16 v[88:91], v[24:27], v[44:47], v[88:91]
    v_mfma_f32_16x16x32_bf16 v[84:87], v[28:31], v[36:39], v[84:87]
    v_mfma_f32_16x16x32_bf16 v[92:95], v[28:31], v[44:47], v[92:95]
    v_readfirstlane_b32 s42, v12
    v_readfirstlane_b32 s43, v13
    s_waitcnt vmcnt(0)
    s_nop 1
    v_pk_mul_f32 v[96:97], v[80:81], s[14:15]
    v_pk_mul_f32 v[98:99], v[82:83], s[14:15]
    v_pk_mul_f32 v[100:101], v[84:85], s[14:15]
    v_pk_mul_f32 v[102:103], v[86:87], s[14:15]
    v_pk_mul_f32 v[104:105], v[88:89], s[14:15]
    v_pk_mul_f32 v[106:107], v[90:91], s[14:15]
    v_pk_mul_f32 v[108:109], v[92:93], s[14:15]
    v_pk_mul_f32 v[110:111], v[94:95], s[14:15]
    s_mov_b32 s76, 0x358637bd
    s_mov_b32 s77, 0x358637bd
    v_exp_f32_e64 v96, v96 clamp
    v_max_f32 v80, 0, v80
    v_exp_f32_e64 v97, v97 clamp
    v_max_f32 v81, 0, v81
    v_exp_f32_e64 v98, v98 clamp
    v_max_f32 v82, 0, v82
    v_exp_f32_e64 v99, v99 clamp
    v_max_f32 v83, 0, v83
    v_exp_f32_e64 v100, v100 clamp
    v_max_f32 v84, 0, v84
    v_exp_f32_e64 v101, v101 clamp
    v_max_f32 v85, 0, v85
    v_exp_f32_e64 v102, v102 clamp
    v_max_f32 v86, 0, v86
    v_exp_f32_e64 v103, v103 clamp
    v_max_f32 v87, 0, v87
    v_exp_f32_e64 v104, v104 clamp
    v_max_f32 v88, 0, v88
    v_exp_f32_e64 v105, v105 clamp
    v_max_f32 v89, 0, v89
    v_exp_f32_e64 v106, v106 clamp
    v_max_f32 v90, 0, v90
    v_exp_f32_e64 v107, v107 clamp
    v_max_f32 v91, 0, v91
    v_exp_f32_e64 v108, v108 clamp
    v_max_f32 v92, 0, v92
    v_exp_f32_e64 v109, v109 clamp
    v_max_f32 v93, 0, v93
    v_exp_f32_e64 v110, v110 clamp
    v_max_f32 v94, 0, v94
    v_exp_f32_e64 v111, v111 clamp
    v_max_f32 v95, 0, v95
    v_pk_add_f32 v[80:81], v[80:81], v[96:97]
    v_pk_add_f32 v[82:83], v[82:83], v[98:99]
    v_pk_add_f32 v[84:85], v[84:85], v[100:101]
    v_pk_add_f32 v[86:87], v[86:87], v[102:103]
    v_pk_add_f32 v[88:89], v[88:89], v[104:105]
    v_pk_add_f32 v[90:91], v[90:91], v[106:107]
    v_pk_add_f32 v[92:93], v[92:93], v[108:109]
    v_pk_add_f32 v[94:95], v[94:95], v[110:111]
    v_pk_add_f32 v[80:81], v[80:81], s[76:77]
    v_pk_add_f32 v[82:83], v[82:83], s[76:77]
    v_pk_add_f32 v[84:85], v[84:85], s[76:77]
    v_pk_add_f32 v[86:87], v[86:87], s[76:77]
    v_pk_add_f32 v[88:89], v[88:89], s[76:77]
    v_pk_add_f32 v[90:91], v[90:91], s[76:77]
    v_pk_add_f32 v[92:93], v[92:93], s[76:77]
    v_pk_add_f32 v[94:95], v[94:95], s[76:77]
    s_lshl_b32 s6, s11, 2
    s_lshr_b32 s7, s5, 1
    s_add_u32 s6, s6, s7
    s_mul_i32 s6, s6, 28672
    s_lshl_b32 s7, s12, 11
    s_add_u32 s6, s6, s7
    s_and_b32 s7, s5, 1
    s_lshl_b32 s7, s7, 10
    s_add_u32 s6, s6, s7
    s_add_u32 s7, s6, 14336
    v_lshrrev_b32 v1, 4, v7
    v_and_b32 v2, 1, v1
    v_lshrrev_b32 v1, 1, v1
    v_lshl_or_b32 v1, v2, 1, v1
    v_and_b32 v2, 15, v7
    v_lshlrev_b32 v2, 4, v2
    v_lshl_add_u32 v0, v1, 8, v2
    v_cvt_pk_bf16_f32 v112, v80, v81
    v_cvt_pk_bf16_f32 v113, v82, v83
    v_cvt_pk_bf16_f32 v114, v84, v85
    v_cvt_pk_bf16_f32 v115, v86, v87
    v_cvt_pk_bf16_f32 v116, v88, v89
    v_cvt_pk_bf16_f32 v117, v90, v91
    v_cvt_pk_bf16_f32 v118, v92, v93
    v_cvt_pk_bf16_f32 v119, v94, v95
    v_permlane16_swap_b32 v112, v114
    v_permlane16_swap_b32 v113, v115
    buffer_store_dwordx4 v[112:115], v0, s[52:55], s6 offen sc1
    v_permlane16_swap_b32 v116, v118
    v_permlane16_swap_b32 v117, v119
    buffer_store_dwordx4 v[116:119], v0, s[52:55], s7 offen sc1
    s_cmp_lg_u32 s5, 7
    s_cbranch_scc1 zok_6
    s_mov_b32 s6, 0
    v_mov_b32 v4, 32
zp_7:
    v_readfirstlane_b32 s7, v5
    s_nop 0
    s_cmp_ge_u32 s7, 16
    s_cbranch_scc1 zok_6
    s_sleep 8
    buffer_load_dword v5, v4, s[64:67], 0 offen sc1
    s_add_u32 s6, s6, 1
    s_waitcnt vmcnt(0)
    s_cmp_lt_u32 s6, 0x10000
    s_cbranch_scc1 zp_7
zok_6:
    s_waitcnt vmcnt(0)
    s_barrier
    s_cmp_eq_u32 s5, 7
    s_cbranch_scc1 q7_8
    s_sub_u32 s10, s4, 28
    s_cmp_ge_u32 s10, 16
    s_cselect_b32 s6, 2, 0
    s_sub_u32 s10, s10, s6
    s_mul_i32 s6, s10, 21846
    s_lshr_b32 s6, s6, 16
    s_mul_i32 s7, s6, 3
    s_sub_u32 s7, s10, s7
    s_and_b32 s8, s3, 1
    s_lshl_b32 s8, s8, 2
    s_add_u32 s9, s7, s8
    s_sub_u32 s7, s10, 24
    s_add_u32 s7, s7, s8
    s_cmp_ge_u32 s10, 24
    s_cselect_b32 s9, 3, s9
    s_cselect_b32 s6, s7, s6
    s_lshr_b32 s7, s3, 1
    s_lshl_b32 s7, s7, 3
    s_add_u32 s8, s6, s7
    s_mov_b32 s68, s20
    s_mov_b32 s69, s21
    s_mov_b32 s70, 0x62000
    s_mov_b32 s71, 0x00020000
    v_lshrrev_b32 v0, 3, v7
    v_bfe_u32 v14, v7, 1, 2
    v_lshrrev_b32 v13, 2, v0
    v_xor_b32 v14, v14, v13
    s_and_b32 s6, s5, 1
    s_lshl_b32 s6, s6, 1
    v_xor_b32 v14, s6, v14
    v_and_b32 v13, 1, v7
    v_lshl_or_b32 v14, v14, 1, v13
    s_lshl_b32 s6, s5, 3
    v_add_u32 v0, s6, v0
    v_mul_u32_u24 v0, 896, v0
    v_lshl_add_u32 v14, v14, 4, v0
    s_lshl_b32 s6, s5, 10
    s_add_u32 m0, s6, 0
    s_lshl_b32 s6, s9, 7
    s_add_u32 s6, s6, 0
    buffer_load_dwordx4 v14, s[68:71], s6 offen lds
    s_lshl_b32 s6, s5, 10
    s_add_u32 m0, s6, 8192
    s_lshl_b32 s6, s9, 7
    s_add_u32 s6, s6, 57344
    buffer_load_dwordx4 v14, s[68:71], s6 offen lds
    s_lshl_b32 s6, s5, 10
    s_add_u32 m0, s6, 16384
    s_lshl_b32 s6, s9, 7
    s_add_u32 s6, s6, 114688
    buffer_load_dwordx4 v14, s[68:71], s6 offen lds
    s_lshl_b32 s6, s5, 10
    s_add_u32 m0, s6, 24576
    s_lshl_b32 s6, s9, 7
    s_add_u32 s6, s6, 172032
    buffer_load_dwordx4 v14, s[68:71], s6 offen lds
    s_lshl_b32 s6, s5, 10
    s_add_u32 m0, s6, 32768
    s_lshl_b32 s6, s9, 7
    s_add_u32 s6, s6, 229376
    buffer_load_dwordx4 v14, s[68:71], s6 offen lds
    s_lshl_b32 s6, s5, 10
    s_add_u32 m0, s6, 40960
    s_lshl_b32 s6, s9, 7
    s_add_u32 s6, s6, 286720
    buffer_load_dwordx4 v14, s[68:71], s6 offen lds
    s_branch A2_entry
q7_8:
    s_cmp_lg_u32 s5, 7
    s_cbranch_scc1 arrq_9
    s_lshl_b32 s6, s11, 8
    s_add_u32 s6, s6, 67584
    v_mov_b32 v1, s6
    v_mov_b32 v2, 1
    s_mov_b64 exec, 1
    buffer_atomic_add v2, v1, s[56:59], 0 offen sc0 sc1
    s_mov_b64 exec, -1
    s_waitcnt vmcnt(0)
    v_readfirstlane_b32 s7, v2
    s_nop 0
    s_cmp_lg_u32 s7, 6
    s_cbranch_scc1 arrq_9
    s_and_b32 s6, s11, 3
    s_mul_i32 s7, s6, 6
    v_cmp_le_u32 vcc, 6, v7
    s_nop 1
    v_cndmask_b32 v2, 0, 1, vcc
    v_mul_u32_u24 v1, 6, v2
    v_sub_u32 v1, v7, v1
    v_add_u32 v1, s7, v1
    s_lshl_b32 s7, s6, 1
    v_add_u32 v3, s7, v7
    v_and_b32 v3, 3, v3
    v_add_u32 v3, 24, v3
    s_lshr_b32 s7, s6, 1
    v_mov_b32 v4, s7
    v_cmp_le_u32 vcc, 12, v7
    s_nop 1
    v_cndmask_b32 v1, v1, v3, vcc
    v_cndmask_b32 v2, v2, v4, vcc
    v_cmp_le_u32 vcc, 14, v1
    s_nop 1
    v_cndmask_b32 v3, 0, 2, vcc
    v_add3_u32 v1, v1, v3, 28
    v_lshl_add_u32 v1, v1, 3, v2
    v_lshlrev_b32 v1, 7, v1
    s_and_b32 s6, s3, 6
    s_lshl_b32 s6, s6, 7
    v_mov_b32 v2, 1
    s_mov_b64 exec, 0x3fff
    buffer_atomic_add v2, v1, s[72:75], s6 offen offset:4 sc1
    s_mov_b64 exec, -1
    s_mov_b32 s6, 71680
    v_mov_b32 v1, s6
    v_mov_b32 v2, 1
    s_mov_b64 exec, 1
    buffer_atomic_add v2, v1, s[56:59], 0 offen sc0 sc1
    s_mov_b64 exec, -1
    s_waitcnt vmcnt(0)
    v_readfirstlane_b32 s7, v2
    s_nop 0
    s_cmp_lg_u32 s7, 23
    s_cbranch_scc1 arrq_9
    v_lshlrev_b32 v1, 7, v7
    v_mov_b32 v2, 1
    s_mov_b32 s6, 28672
    buffer_atomic_add v2, v1, s[72:75], s6 offen sc1
    s_mov_b32 s6, 36864
    buffer_atomic_add v2, v1, s[72:75], s6 offen sc1
    s_mov_b32 s6, 45056
    buffer_atomic_add v2, v1, s[72:75], s6 offen sc1
    s_mov_b32 s6, 53248
    s_mov_b32 s10, -1
    s_mov_b32 s11, 0xffff
    s_mov_b64 exec, s[10:11]
    buffer_atomic_add v2, v1, s[72:75], s6 offen sc1
    s_mov_b64 exec, -1
arrq_9:
    s_sub_u32 s10, s4, 28
    s_cmp_ge_u32 s10, 16
    s_cselect_b32 s6, 2, 0
    s_sub_u32 s10, s10, s6
    s_mul_i32 s6, s10, 21846
    s_lshr_b32 s6, s6, 16
    s_mul_i32 s7, s6, 3
    s_sub_u32 s7, s10, s7
    s_and_b32 s8, s3, 1
    s_lshl_b32 s8, s8, 2
    s_add_u32 s9, s7, s8
    s_sub_u32 s7, s10, 24
    s_add_u32 s7, s7, s8
    s_cmp_ge_u32 s10, 24
    s_cselect_b32 s9, 3, s9
    s_cselect_b32 s6, s7, s6
    s_lshr_b32 s7, s3, 1
    s_lshl_b32 s7, s7, 3
    s_add_u32 s8, s6, s7
    s_mov_b32 s68, s20
    s_mov_b32 s69, s21
    s_mov_b32 s70, 0x62000
    s_mov_b32 s71, 0x00020000
    v_lshrrev_b32 v0, 3, v7
    v_bfe_u32 v14, v7, 1, 2
    v_lshrrev_b32 v13, 2, v0
    v_xor_b32 v14, v14, v13
    s_and_b32 s6, s5, 1
    s_lshl_b32 s6, s6, 1
    v_xor_b32 v14, s6, v14
    v_and_b32 v13, 1, v7
    v_lshl_or_b32 v14, v14, 1, v13
    s_lshl_b32 s6, s5, 3
    v_add_u32 v0, s6, v0
    v_mul_u32_u24 v0, 896, v0
    v_lshl_add_u32 v14, v14, 4, v0
    s_lshl_b32 s6, s5, 10
    s_add_u32 m0, s6, 0
    s_lshl_b32 s6, s9, 7
    s_add_u32 s6, s6, 0
    buffer_load_dwordx4 v14, s[68:71], s6 offen lds
    s_lshl_b32 s6, s5, 10
    s_add_u32 m0, s6, 8192
    s_lshl_b32 s6, s9, 7
    s_add_u32 s6, s6, 57344
    buffer_load_dwordx4 v14, s[68:71], s6 offen lds
    s_lshl_b32 s6, s5, 10
    s_add_u32 m0, s6, 16384
    s_lshl_b32 s6, s9, 7
    s_add_u32 s6, s6, 114688
    buffer_load_dwordx4 v14, s[68:71], s6 offen lds
    s_lshl_b32 s6, s5, 10
    s_add_u32 m0, s6, 24576
    s_lshl_b32 s6, s9, 7
    s_add_u32 s6, s6, 172032
    buffer_load_dwordx4 v14, s[68:71], s6 offen lds
    s_lshl_b32 s6, s5, 10
    s_add_u32 m0, s6, 32768
    s_lshl_b32 s6, s9, 7
    s_add_u32 s6, s6, 229376
    buffer_load_dwordx4 v14, s[68:71], s6 offen lds
    s_lshl_b32 s6, s5, 10
    s_add_u32 m0, s6, 40960
    s_lshl_b32 s6, s9, 7
    s_add_u32 s6, s6, 286720
    buffer_load_dwordx4 v14, s[68:71], s6 offen lds
A2_entry:
    s_nop 7
    s_sub_u32 s10, s4, 28
    s_and_b32 s6, s10, 30
    s_cmp_eq_u32 s6, 14
    s_cbranch_scc1 A_end
    s_lshl_b32 s6, s5, 10
    s_add_u32 m0, s6, 49152
    s_lshl_b32 s6, s9, 7
    s_add_u32 s6, s6, 344064
    buffer_load_dwordx4 v14, s[68:71], s6 offen lds
    s_mov_b32 s60, s36
    s_mov_b32 s61, s37
    s_mov_b32 s62, 0x380000
    s_mov_b32 s63, 0x00020000
    v_lshrrev_b32 v2, 4, v7
    v_bfe_u32 v3, v7, 2, 2
    v_and_b32 v6, 3, v7
    s_and_b32 s6, s5, 3
    v_xor_b32 v0, s6, v3
    v_lshlrev_b32 v0, 5, v0
    v_lshl_add_u32 v0, v6, 3, v0
    v_lshl_add_u32 v0, v2, 7, v0
    v_lshl_add_u32 v96, v3, 9, v0
    v_xor_b32 v97, 64, v96
    v_lshrrev_b32 v1, 1, v3
    v_mul_u32_u24 v1, 7168, v1
    v_and_b32 v3, 1, v3
    v_lshl_add_u32 v1, v3, 9, v1
    v_add_u32 v98, v1, v0
    v_lshlrev_b32 v5, 4, v7
    s_cmp_lg_u32 s5, 0
    s_cbranch_scc1 pw_10
    s_mov_b32 s6, 0
    v_mov_b32 v3, s100
    s_mov_b64 exec, 1
poll_11:
    buffer_load_dwordx2 v[0:1], v3, s[72:75], 0 offen sc1
    s_add_u32 s6, s6, 1
    s_waitcnt vmcnt(0)
    v_cmp_ne_u64 vcc, s[42:43], v[0:1]
    s_cbranch_vccnz polld_12
    s_sleep 2
    s_cmp_lt_u32 s6, 0x10000
    s_cbranch_scc1 poll_11
polld_12:
    s_mov_b64 exec, -1
pw_10:
    s_waitcnt vmcnt(0)
    s_barrier
    s_mul_i32 s6, s8, 57344
    s_mul_i32 s7, s5, 1792
    s_add_u32 s76, s6, s7
    s_add_u32 s77, s76, 14336
    s_add_u32 s78, s76, 28672
    s_add_u32 s79, s76, 43008
    buffer_load_dwordx4 v[64:67], v5, s[52:55], s76 offen offset:0 sc1
    buffer_load_dwordx4 v[68:71], v5, s[52:55], s76 offen offset:768 sc1
    buffer_load_dwordx4 v[72:75], v5, s[52:55], s77 offen offset:0 sc1
    buffer_load_dwordx4 v[76:79], v5, s[52:55], s77 offen offset:768 sc1
    buffer_load_dwordx4 v[80:83], v5, s[52:55], s78 offen offset:0 sc1
    buffer_load_dwordx4 v[84:87], v5, s[52:55], s78 offen offset:768 sc1
    buffer_load_dwordx4 v[88:91], v5, s[52:55], s79 offen offset:0 sc1
    buffer_load_dwordx4 v[92:95], v5, s[52:55], s79 offen offset:768 sc1
    ds_read_b64_tr_b16 v[8:9], v96 offset:0
    ds_read_b64_tr_b16 v[10:11], v96 offset:2048
    ds_read_b64_tr_b16 v[40:41], v96 offset:4096
    ds_read_b64_tr_b16 v[12:13], v97 offset:7168
    ds_read_b64_tr_b16 v[14:15], v97 offset:9216
    ds_read_b64_tr_b16 v[42:43], v97 offset:11264
    ds_read_b64_tr_b16 v[16:17], v96 offset:14336
    ds_read_b64_tr_b16 v[18:19], v96 offset:16384
    ds_read_b64_tr_b16 v[44:45], v96 offset:18432
    ds_read_b64_tr_b16 v[20:21], v97 offset:21504
    ds_read_b64_tr_b16 v[22:23], v97 offset:23552
    ds_read_b64_tr_b16 v[46:47], v97 offset:25600
    ds_read_b64_tr_b16 v[24:25], v96 offset:28672
    ds_read_b64_tr_b16 v[26:27], v96 offset:30720
    ds_read_b64_tr_b16 v[48:49], v96 offset:32768
    s_waitcnt lgkmcnt(12)
    ds_read_b64_tr_b16 v[28:29], v97 offset:35840
    ds_read_b64_tr_b16 v[30:31], v97 offset:37888
    ds_read_b64_tr_b16 v[50:51], v97 offset:39936
    s_waitcnt lgkmcnt(12)
    ds_read_b64_tr_b16 v[32:33], v96 offset:43008
    ds_read_b64_tr_b16 v[34:35], v96 offset:45056
    ds_read_b64_tr_b16 v[52:53], v96 offset:47104
    s_waitcnt lgkmcnt(12)
    ds_read_b64_tr_b16 v[36:37], v97 offset:50176
    ds_read_b64_tr_b16 v[38:39], v97 offset:52224
    ds_read_b64_tr_b16 v[54:55], v97 offset:54272
    s_waitcnt lgkmcnt(12)
    ds_read_b64_tr_b16 v[56:57], v98 offset:6144
    ds_read_b64_tr_b16 v[58:59], v98 offset:20480
    ds_read_b64_tr_b16 v[60:61], v98 offset:34816
    s_waitcnt lgkmcnt(12)
    ds_read_b64_tr_b16 v[62:63], v98 offset:49152
    s_lshl_b32 s12, s5, 13
    s_lshl_b32 s6, s5, 10
    v_add_u32 v2, s6, v5
    s_lshr_b32 s6, s5, 1
    s_lshl_b32 s6, s6, 10
    s_and_b32 s7, s5, 1
    s_lshl_b32 s7, s7, 3
    s_add_u32 s6, s6, s7
    s_add_u32 s6, s6, 8192
    v_add_u32 v3, s6, v5
    s_lshr_b32 s6, s5, 2
    s_lshl_b32 s6, s6, 10
    s_and_b32 s7, s5, 3
    s_lshl_b32 s7, s7, 2
    s_add_u32 s6, s6, s7
    s_add_u32 s6, s6, 12288
    v_add_u32 v4, s6, v5
    s_mov_b32 s10, 0
    s_mov_b32 s11, 0xffff0000
    s_mov_b32 s13, 0x358637bd
    s_waitcnt vmcnt(0)
    s_mov_b64 exec, s[10:11]
    v_mov_b32 v66, 0
    v_mov_b32 v67, 0
    v_mov_b32 v74, 0
    v_mov_b32 v75, 0
    v_mov_b32 v82, 0
    v_mov_b32 v83, 0
    v_mov_b32 v90, 0
    v_mov_b32 v91, 0
    s_mov_b64 exec, 0xffff
    v_mov_b32 v68, 0
    v_mov_b32 v69, 0
    v_mov_b32 v76, 0
    v_mov_b32 v77, 0
    v_mov_b32 v84, 0
    v_mov_b32 v85, 0
    v_mov_b32 v92, 0
    v_mov_b32 v93, 0
    s_mov_b64 exec, -1
    s_waitcnt lgkmcnt(0)
    s_cmp_lg_u32 s5, 0
    s_cbranch_scc1 aw_13
    s_mov_b32 s6, 0
    v_mov_b32 v0, s100
    s_mov_b64 exec, 1
poll_14:
    buffer_load_dword v1, v0, s[72:75], 0 offen offset:0 sc1
    s_add_u32 s6, s6, 1
    s_waitcnt vmcnt(0)
    v_cmp_ne_u32 vcc, s42, v1
    s_cbranch_vccnz polld_15
    s_sleep 2
    s_cmp_lt_u32 s6, 0x10000
    s_cbranch_scc1 poll_14
polld_15:
    s_mov_b64 exec, -1
aw_13:
    s_barrier
    s_add_u32 s6, s12, 4096
    buffer_load_dwordx4 v[96:99], v5, s[56:59], s12 offen offset:0 sc1
    buffer_load_dwordx4 v[100:103], v5, s[56:59], s12 offen offset:1024 sc1
    buffer_load_dwordx4 v[104:107], v5, s[56:59], s12 offen offset:2048 sc1
    buffer_load_dwordx4 v[108:111], v5, s[56:59], s12 offen offset:3072 sc1
    buffer_load_dwordx4 v[112:115], v5, s[56:59], s6 offen offset:0 sc1
    buffer_load_dwordx4 v[116:119], v5, s[56:59], s6 offen offset:1024 sc1
    buffer_load_dwordx4 v[120:123], v5, s[56:59], s6 offen offset:2048 sc1
    buffer_load_dwordx4 v[124:127], v5, s[56:59], s6 offen offset:3072 sc1
    v_and_b32 v0, 31, v7
    v_mul_u32_u24 v0, 1792, v0
    v_lshrrev_b32 v1, 5, v7
    v_lshl_add_u32 v6, v1, 4, v0
    s_lshr_b32 s10, s5, 2
    s_lshl_b32 s7, s8, 1
    s_add_u32 s7, s7, s10
    s_mul_i32 s14, s7, 57344
    s_lshl_b32 s7, s9, 7
    s_add_u32 s14, s14, s7
    s_and_b32 s7, s5, 3
    s_lshl_b32 s7, s7, 5
    s_add_u32 s14, s14, s7
    s_mul_i32 s15, s10, 28672
    s_waitcnt vmcnt(6)
    v_cvt_pk_bf16_f32 v96, v96, v97
    v_cvt_pk_bf16_f32 v97, v98, v99
    v_cvt_pk_bf16_f32 v98, v100, v101
    v_cvt_pk_bf16_f32 v99, v102, v103
    s_waitcnt vmcnt(4)
    v_cvt_pk_bf16_f32 v100, v104, v105
    v_cvt_pk_bf16_f32 v101, v106, v107
    v_cvt_pk_bf16_f32 v102, v108, v109
    v_cvt_pk_bf16_f32 v103, v110, v111
    s_waitcnt vmcnt(2)
    v_cvt_pk_bf16_f32 v104, v112, v113
    v_cvt_pk_bf16_f32 v105, v114, v115
    v_cvt_pk_bf16_f32 v106, v116, v117
    v_cvt_pk_bf16_f32 v107, v118, v119
    s_waitcnt vmcnt(0)
    v_cvt_pk_bf16_f32 v108, v120, v121
    v_cvt_pk_bf16_f32 v109, v122, v123
    v_cvt_pk_bf16_f32 v110, v124, v125
    v_cvt_pk_bf16_f32 v111, v126, v127
    v_mfma_f32_16x16x32_bf16 v[116:119], v[100:103], v[64:67], 0
    v_mfma_f32_16x16x32_bf16 v[112:115], v[96:99], v[64:67], 0
    v_mfma_f32_16x16x32_bf16 v[124:127], v[108:111], v[68:71], 0
    v_mfma_f32_16x16x32_bf16 v[120:123], v[104:107], v[68:71], 0
    s_nop 4
    v_add_f32 v0, s13, v119
    v_rcp_f32 v0, v0
    s_nop 0
    v_pk_mul_f32 v[112:113], v[0:1], v[112:113] op_sel:[0,0] op_sel_hi:[0,1]
    v_pk_mul_f32 v[114:115], v[0:1], v[114:115] op_sel:[0,0] op_sel_hi:[0,1]
    v_pk_mul_f32 v[116:117], v[0:1], v[116:117] op_sel:[0,0] op_sel_hi:[0,1]
    v_pk_mul_f32 v[118:119], v[0:1], v[118:119] op_sel:[0,0] op_sel_hi:[0,1]
    v_cvt_pk_bf16_f32 v64, v112, v113
    v_cvt_pk_bf16_f32 v65, v114, v115
    v_cvt_pk_bf16_f32 v66, v116, v117
    v_mov_b32 v1, v118
    v_mfma_f32_16x16x32_bf16 v[116:119], v[100:103], v[72:75], 0
    v_mfma_f32_16x16x32_bf16 v[112:115], v[96:99], v[72:75], 0
    v_add_f32 v0, s13, v127
    v_rcp_f32 v0, v0
    s_nop 0
    v_pk_mul_f32 v[120:121], v[0:1], v[120:121] op_sel:[0,0] op_sel_hi:[0,1]
    v_pk_mul_f32 v[122:123], v[0:1], v[122:123] op_sel:[0,0] op_sel_hi:[0,1]
    v_pk_mul_f32 v[124:125], v[0:1], v[124:125] op_sel:[0,0] op_sel_hi:[0,1]
    v_pk_mul_f32 v[126:127], v[0:1], v[126:127] op_sel:[0,0] op_sel_hi:[0,1]
    v_cvt_pk_bf16_f32 v67, v1, v120
    v_cvt_pk_bf16_f32 v68, v121, v122
    v_cvt_pk_bf16_f32 v69, v123, v124
    v_cvt_pk_bf16_f32 v70, v125, v126
    ds_write_b128 v2, v[64:67] offset:0
    ds_write_b64 v3, v[68:69] offset:0
    ds_write_b32 v4, v70 offset:0
    v_mfma_f32_16x16x32_bf16 v[124:127], v[108:111], v[76:79], 0
    v_mfma_f32_16x16x32_bf16 v[120:123], v[104:107], v[76:79], 0
    v_add_f32 v0, s13, v119
    v_rcp_f32 v0, v0
    s_nop 0
    v_pk_mul_f32 v[112:113], v[0:1], v[112:113] op_sel:[0,0] op_sel_hi:[0,1]
    v_pk_mul_f32 v[114:115], v[0:1], v[114:115] op_sel:[0,0] op_sel_hi:[0,1]
    v_pk_mul_f32 v[116:117], v[0:1], v[116:117] op_sel:[0,0] op_sel_hi:[0,1]
    v_pk_mul_f32 v[118:119], v[0:1], v[118:119] op_sel:[0,0] op_sel_hi:[0,1]
    v_cvt_pk_bf16_f32 v72, v112, v113
    v_cvt_pk_bf16_f32 v73, v114, v115
    v_cvt_pk_bf16_f32 v74, v116, v117
    v_mov_b32 v1, v118
    v_mfma_f32_16x16x32_bf16 v[116:119], v[100:103], v[80:83], 0
    v_mfma_f32_16x16x32_bf16 v[112:115], v[96:99], v[80:83], 0
    v_add_f32 v0, s13, v127
    v_rcp_f32 v0, v0
    s_nop 0
    v_pk_mul_f32 v[120:121], v[0:1], v[120:121] op_sel:[0,0] op_sel_hi:[0,1]
    v_pk_mul_f32 v[122:123], v[0:1], v[122:123] op_sel:[0,0] op_sel_hi:[0,1]
    v_pk_mul_f32 v[124:125], v[0:1], v[124:125] op_sel:[0,0] op_sel_hi:[0,1]
    v_pk_mul_f32 v[126:127], v[0:1], v[126:127] op_sel:[0,0] op_sel_hi:[0,1]
    v_cvt_pk_bf16_f32 v75, v1, v120
    v_cvt_pk_bf16_f32 v76, v121, v122
    v_cvt_pk_bf16_f32 v77, v123, v124
    v_cvt_pk_bf16_f32 v78, v125, v126
    ds_write_b128 v2, v[72:75] offset:14336
    ds_write_b64 v3, v[76:77] offset:14336
    ds_write_b32 v4, v78 offset:14336
    v_mfma_f32_16x16x32_bf16 v[124:127], v[108:111], v[84:87], 0
    v_mfma_f32_16x16x32_bf16 v[120:123], v[104:107], v[84:87], 0
    v_add_f32 v0, s13, v119
    v_rcp_f32 v0, v0
    s_nop 0
    v_pk_mul_f32 v[112:113], v[0:1], v[112:113] op_sel:[0,0] op_sel_hi:[0,1]
    v_pk_mul_f32 v[114:115], v[0:1], v[114:115] op_sel:[0,0] op_sel_hi:[0,1]
    v_pk_mul_f32 v[116:117], v[0:1], v[116:117] op_sel:[0,0] op_sel_hi:[0,1]
    v_pk_mul_f32 v[118:119], v[0:1], v[118:119] op_sel:[0,0] op_sel_hi:[0,1]
    v_cvt_pk_bf16_f32 v80, v112, v113
    v_cvt_pk_bf16_f32 v81, v114, v115
    v_cvt_pk_bf16_f32 v82, v116, v117
    v_mov_b32 v1, v118
    v_mfma_f32_16x16x32_bf16 v[116:119], v[100:103], v[88:91], 0
    v_mfma_f32_16x16x32_bf16 v[112:115], v[96:99], v[88:91], 0
    v_add_f32 v0, s13, v127
    v_rcp_f32 v0, v0
    s_nop 0
    v_pk_mul_f32 v[120:121], v[0:1], v[120:121] op_sel:[0,0] op_sel_hi:[0,1]
    v_pk_mul_f32 v[122:123], v[0:1], v[122:123] op_sel:[0,0] op_sel_hi:[0,1]
    v_pk_mul_f32 v[124:125], v[0:1], v[124:125] op_sel:[0,0] op_sel_hi:[0,1]
    v_pk_mul_f32 v[126:127], v[0:1], v[126:127] op_sel:[0,0] op_sel_hi:[0,1]
    v_cvt_pk_bf16_f32 v83, v1, v120
    v_cvt_pk_bf16_f32 v84, v121, v122
    v_cvt_pk_bf16_f32 v85, v123, v124
    v_cvt_pk_bf16_f32 v86, v125, v126
    ds_write_b128 v2, v[80:83] offset:28672
    ds_write_b64 v3, v[84:85] offset:28672
    ds_write_b32 v4, v86 offset:28672
    v_mfma_f32_16x16x32_bf16 v[124:127], v[108:111], v[92:95], 0
    v_mfma_f32_16x16x32_bf16 v[120:123], v[104:107], v[92:95], 0
    v_add_f32 v0, s13, v119
    v_rcp_f32 v0, v0
    s_nop 0
    v_pk_mul_f32 v[112:113], v[0:1], v[112:113] op_sel:[0,0] op_sel_hi:[0,1]
    v_pk_mul_f32 v[114:115], v[0:1], v[114:115] op_sel:[0,0] op_sel_hi:[0,1]
    v_pk_mul_f32 v[116:117], v[0:1], v[116:117] op_sel:[0,0] op_sel_hi:[0,1]
    v_pk_mul_f32 v[118:119], v[0:1], v[118:119] op_sel:[0,0] op_sel_hi:[0,1]
    v_cvt_pk_bf16_f32 v88, v112, v113
    v_cvt_pk_bf16_f32 v89, v114, v115
    v_cvt_pk_bf16_f32 v90, v116, v117
    v_mov_b32 v1, v118
    v_add_f32 v0, s13, v127
    v_rcp_f32 v0, v0
    s_nop 0
    v_pk_mul_f32 v[120:121], v[0:1], v[120:121] op_sel:[0,0] op_sel_hi:[0,1]
    v_pk_mul_f32 v[122:123], v[0:1], v[122:123] op_sel:[0,0] op_sel_hi:[0,1]
    v_pk_mul_f32 v[124:125], v[0:1], v[124:125] op_sel:[0,0] op_sel_hi:[0,1]
    v_pk_mul_f32 v[126:127], v[0:1], v[126:127] op_sel:[0,0] op_sel_hi:[0,1]
    v_cvt_pk_bf16_f32 v91, v1, v120
    v_cvt_pk_bf16_f32 v92, v121, v122
    v_cvt_pk_bf16_f32 v93, v123, v124
    v_cvt_pk_bf16_f32 v94, v125, v126
    ds_write_b128 v2, v[88:91] offset:43008
    ds_write_b64 v3, v[92:93] offset:43008
    ds_write_b32 v4, v94 offset:43008
    v_add_u32 v2, s15, v5
    s_waitcnt lgkmcnt(0)
    s_barrier
    ds_read_b128 v[64:67], v2 offset:0
    ds_read_b128 v[68:71], v2 offset:14336
    ds_read_b128 v[72:75], v2 offset:1024
    ds_read_b128 v[76:79], v2 offset:15360
    ds_read_b128 v[80:83], v2 offset:2048
    ds_read_b128 v[84:87], v2 offset:16384
    ds_read_b128 v[88:91], v2 offset:3072
    s_waitcnt lgkmcnt(6)
    v_mfma_f32_16x16x32_bf16 v[96:99], v[8:11], v[64:67], 0
    ds_read_b128 v[92:95], v2 offset:17408
    s_waitcnt lgkmcnt(6)
    v_mfma_f32_16x16x32_bf16 v[100:103], v[8:11], v[68:71], 0
    ds_read_b128 v[64:67], v2 offset:4096
    s_waitcnt lgkmcnt(6)
    v_mfma_f32_16x16x32_bf16 v[96:99], v[12:15], v[72:75], v[96:99]
    ds_read_b128 v[68:71], v2 offset:18432
    s_waitcnt lgkmcnt(6)
    v_mfma_f32_16x16x32_bf16 v[100:103], v[12:15], v[76:79], v[100:103]
    ds_read_b128 v[72:75], v2 offset:5120
    s_waitcnt lgkmcnt(6)
    v_mfma_f32_16x16x32_bf16 v[96:99], v[16:19], v[80:83], v[96:99]
    ds_read_b128 v[76:79], v2 offset:19456
    s_waitcnt lgkmcnt(6)
    v_mfma_f32_16x16x32_bf16 v[100:103], v[16:19], v[84:87], v[100:103]
    ds_read_b128 v[80:83], v2 offset:6144
    s_waitcnt lgkmcnt(6)
    v_mfma_f32_16x16x32_bf16 v[96:99], v[20:23], v[88:91], v[96:99]
    ds_read_b128 v[84:87], v2 offset:20480
    s_waitcnt lgkmcnt(6)
    v_mfma_f32_16x16x32_bf16 v[100:103], v[20:23], v[92:95], v[100:103]
    ds_read_b128 v[88:91], v2 offset:7168
    s_waitcnt lgkmcnt(6)
    v_mfma_f32_16x16x32_bf16 v[96:99], v[24:27], v[64:67], v[96:99]
    ds_read_b128 v[92:95], v2 offset:21504
    s_waitcnt lgkmcnt(6)
    v_mfma_f32_16x16x32_bf16 v[100:103], v[24:27], v[68:71], v[100:103]
    ds_read_b128 v[64:67], v2 offset:8192
    s_waitcnt lgkmcnt(6)
    v_mfma_f32_16x16x32_bf16 v[96:99], v[28:31], v[72:75], v[96:99]
    ds_read_b128 v[68:71], v2 offset:22528
    s_waitcnt lgkmcnt(6)
    v_mfma_f32_16x16x32_bf16 v[100:103], v[28:31], v[76:79], v[100:103]
    ds_read_b128 v[72:75], v2 offset:9216
    s_waitcnt lgkmcnt(6)
    v_mfma_f32_16x16x32_bf16 v[96:99], v[32:35], v[80:83], v[96:99]
    ds_read_b128 v[76:79], v2 offset:23552
    s_waitcnt lgkmcnt(6)
    v_mfma_f32_16x16x32_bf16 v[100:103], v[32:35], v[84:87], v[100:103]
    ds_read_b128 v[80:83], v2 offset:10240
    s_waitcnt lgkmcnt(6)
    v_mfma_f32_16x16x32_bf16 v[96:99], v[36:39], v[88:91], v[96:99]
    ds_read_b128 v[84:87], v2 offset:24576
    s_waitcnt lgkmcnt(6)
    v_mfma_f32_16x16x32_bf16 v[100:103], v[36:39], v[92:95], v[100:103]
    ds_read_b128 v[88:91], v2 offset:11264
    s_waitcnt lgkmcnt(6)
    v_mfma_f32_16x16x32_bf16 v[96:99], v[40:43], v[64:67], v[96:99]
    ds_read_b128 v[92:95], v2 offset:25600
    s_waitcnt lgkmcnt(6)
    v_mfma_f32_16x16x32_bf16 v[100:103], v[40:43], v[68:71], v[100:103]
    ds_read_b128 v[64:67], v2 offset:12288
    s_waitcnt lgkmcnt(6)
    v_mfma_f32_16x16x32_bf16 v[96:99], v[44:47], v[72:75], v[96:99]
    ds_read_b128 v[68:71], v2 offset:26624
    s_waitcnt lgkmcnt(6)
    v_mfma_f32_16x16x32_bf16 v[100:103], v[44:47], v[76:79], v[100:103]
    ds_read_b128 v[72:75], v2 offset:13312
    s_waitcnt lgkmcnt(6)
    v_mfma_f32_16x16x32_bf16 v[96:99], v[48:51], v[80:83], v[96:99]
    ds_read_b128 v[76:79], v2 offset:27648
    s_waitcnt lgkmcnt(6)
    v_mfma_f32_16x16x32_bf16 v[100:103], v[48:51], v[84:87], v[100:103]
    s_waitcnt lgkmcnt(5)
    v_mfma_f32_16x16x32_bf16 v[96:99], v[52:55], v[88:91], v[96:99]
    s_waitcnt lgkmcnt(4)
    v_mfma_f32_16x16x32_bf16 v[100:103], v[52:55], v[92:95], v[100:103]
    s_waitcnt lgkmcnt(3)
    v_mfma_f32_16x16x32_bf16 v[96:99], v[56:59], v[64:67], v[96:99]
    s_waitcnt lgkmcnt(2)
    v_mfma_f32_16x16x32_bf16 v[100:103], v[56:59], v[68:71], v[100:103]
    s_waitcnt lgkmcnt(1)
    v_mfma_f32_16x16x32_bf16 v[96:99], v[60:63], v[72:75], v[96:99]
    s_waitcnt lgkmcnt(0)
    v_mfma_f32_16x16x32_bf16 v[100:103], v[60:63], v[76:79], v[100:103]
    s_nop 5
    v_cvt_pk_bf16_f32 v112, v96, v97
    v_cvt_pk_bf16_f32 v113, v98, v99
    v_cvt_pk_bf16_f32 v114, v100, v101
    v_cvt_pk_bf16_f32 v115, v102, v103
    s_nop 0
    v_permlane16_swap_b32 v112, v114
    v_permlane16_swap_b32 v113, v115
    buffer_store_dwordx4 v[112:115], v6, s[60:63], s14 offen
A_end:
    s_endpgm
B_entry:
    s_setprio 3
    s_cmp_ge_u32 s4, 14
    s_cselect_b32 s6, 27, 0
    s_lshl_b32 s7, s4, 1
    s_sub_u32 s7, s7, s6
    s_mul_i32 s8, s3, 28
    s_add_u32 s8, s8, s7
    s_lshr_b32 s9, s8, 5
    s_and_b32 s10, s8, 31
    s_lshr_b32 s11, s8, 1
    s_and_b32 s48, s5, 3
    s_lshr_b32 s49, s5, 2
    s_lshl_b32 s12, s11, 2
    s_add_u32 s12, s12, s48
    v_and_b32 v1, 15, v7
    v_lshrrev_b32 v2, 4, v7
    v_lshrrev_b32 v3, 3, v7
    v_mul_u32_u24 v3, 896, v3
    v_and_b32 v4, 7, v7
    v_lshl_add_u32 v3, v4, 4, v3
    s_lshl_b32 s6, s10, 3
    s_add_u32 s6, s6, s5
    s_mul_i32 s6, s6, 7168
    s_lshl_b32 s7, s9, 7
    s_add_u32 s6, s6, s7
    s_lshl_b32 s7, s5, 10
    s_add_u32 m0, s7, 73728
    v_lshlrev_b32 v4, 2, v7
    s_lshl_b32 s7, s12, 1
    s_add_u32 s7, s7, s49
    s_lshl_b32 s7, s7, 8
    v_add_u32 v4, s7, v4
    s_lshl_b32 s7, s12, 1
    v_mov_b32 v5, s7
    s_add_u32 s100, s8, 512
    s_lshl_b32 s100, s100, 7
    v_mov_b32 v9, s100
    s_waitcnt lgkmcnt(0)
    s_mov_b32 s44, s22
    s_mov_b32 s45, s23
    s_mov_b32 s46, 0x1c0000
    s_mov_b32 s47, 0x00020000
    buffer_load_dwordx4 v3, s[44:47], s6 offen lds
    s_add_u32 s72, s40, 0x480000
    s_addc_u32 s73, s41, 0
    s_mov_b32 s74, 0x20000
    s_mov_b32 s75, 0x00020000
    buffer_load_dwordx2 v[124:125], v9, s[72:75], 0 offen sc1
    s_cmp_lt_u32 s4, 14
    s_cbranch_scc1 nopar_16
    global_load_dword v10, v4, s[24:25]
    global_load_dword v11, v4, s[26:27]
    global_load_dword v12, v4, s[28:29]
    global_load_dword v13, v4, s[30:31]
    global_load_ushort v14, v5, s[32:33]
    global_load_ushort v15, v5, s[34:35]
nopar_16:
    s_add_u32 s52, s40, 0x200000
    s_addc_u32 s53, s41, 0
    s_mov_b32 s54, 0x1c0000
    s_mov_b32 s55, 0x00020000
    s_mov_b32 s64, s38
    s_mov_b32 s65, s39
    s_mov_b32 s66, 0x100
    s_mov_b32 s67, 0x00020000
    s_mov_b32 s60, s36
    s_mov_b32 s61, s37
    s_mov_b32 s62, 0x380000
    s_mov_b32 s63, 0x00020000
    s_cmp_ge_u32 s4, 2
    s_cbranch_scc1 nz_17
    s_add_u32 s56, s40, 0x400000
    s_addc_u32 s57, s41, 0
    s_mov_b32 s58, 0x12000
    s_mov_b32 s59, 0x00020000
    v_mov_b32 v32, 0
    v_mov_b32 v33, 0
    v_lshlrev_b32 v3, 3, v7
    s_lshl_b32 s6, s2, 12
    s_lshl_b32 s7, s5, 9
    s_add_u32 s6, s6, s7
    buffer_store_dwordx2 v[32:33], v3, s[56:59], s6 offen sc1
    s_cmp_lg_u32 s5, 0
    s_cbranch_scc1 nz_17
    s_lshl_b32 s6, s2, 9
    s_add_u32 s6, s6, 65536
    buffer_store_dwordx2 v[32:33], v3, s[56:59], s6 offen sc1
nz_17:
    v_bfe_u32 v3, v7, 2, 2
    v_lshl_add_u32 v3, v2, 3, v3
    v_lshlrev_b32 v3, 7, v3
    v_and_b32 v4, 3, v7
    v_lshl_add_u32 v3, v4, 3, v3
    s_lshl_b32 s6, s48, 5
    s_lshl_b32 s7, s49, 12
    s_add_u32 s6, s6, s7
    s_add_u32 s6, s6, 73728
    v_add_u32 v3, s6, v3
    s_lshl_b32 s6, s9, 6
    s_lshl_b32 s7, s48, 4
    s_add_u32 s6, s6, s7
    s_lshl_b32 s6, s6, 12
    s_lshl_b32 s7, s10, 7
    s_add_u32 s6, s6, s7
    s_lshl_b32 s7, s49, 6
    s_add_u32 s6, s6, s7
    v_lshlrev_b32 v4, 12, v1
    v_lshl_add_u32 v4, v2, 4, v4
    s_mul_i32 s14, s5, 9216
    v_mul_u32_u24 v5, 288, v1
    v_lshl_add_u32 v5, v2, 4, v5
    v_add_u32 v18, s14, v5
    v_min_u32 v6, 8, v1
    v_mul_u32_u24 v6, 288, v6
    v_lshl_add_u32 v6, v2, 4, v6
    v_add_u32 v19, s14, v6
    s_cmp_ge_u32 s4, 14
    s_cbranch_scc1 w1_18
    s_waitcnt vmcnt(0)
w1_18:
    s_waitcnt vmcnt(6)
    s_barrier
    ds_read_b64_tr_b16 v[60:61], v3 offset:0
    ds_read_b64_tr_b16 v[62:63], v3 offset:512
    v_readfirstlane_b32 s42, v124
    v_readfirstlane_b32 s43, v125
    s_waitcnt lgkmcnt(0)
    buffer_store_dwordx4 v[60:63], v4, s[52:55], s6 offen sc1
    s_and_b32 s6, s9, 3
    s_lshl_b32 s6, s6, 6
    s_lshr_b32 s7, s9, 2
    s_lshl_b32 s7, s7, 2
    s_add_u32 s6, s6, s7
    s_add_u32 s51, s6, 4
    s_add_u32 s68, s40, 0x600000
    s_addc_u32 s69, s41, 0
    s_mov_b32 s70, 0x1c0000
    s_mov_b32 s71, 0x00020000
    s_cmp_ge_u32 s4, 14
    s_cbranch_scc1 B_heavy
    s_waitcnt vmcnt(0)
    s_barrier
    s_cmp_ge_u32 s4, 2
    s_cbranch_scc1 zs_19
    s_cmp_lg_u32 s5, 6
    s_cbranch_scc1 zs_19
    v_mov_b32 v3, 32
    v_mov_b32 v4, 1
    s_mov_b64 exec, 1
    buffer_atomic_add v4, v3, s[64:67], 0 offen sc1
    s_mov_b64 exec, -1
zs_19:
    s_cmp_lg_u32 s5, 7
    s_cbranch_scc1 B_join
    v_mov_b32 v3, s51
    v_mov_b32 v4, 1
    s_mov_b64 exec, 1
    buffer_atomic_add v4, v3, s[64:67], 0 offen sc0 sc1
    s_mov_b64 exec, -1
    s_waitcnt vmcnt(0)
    v_readfirstlane_b32 s7, v4
    s_nop 0
    s_cmp_lg_u32 s7, 31
    s_cbranch_scc1 B_join
    v_lshlrev_b32 v3, 7, v7
    v_mov_b32 v4, 1
    s_lshl_b32 s6, s9, 12
    s_add_u32 s6, s6, 65536
    s_mov_b64 exec, 0xffffffff
    buffer_atomic_add v4, v3, s[72:75], s6 offen sc1
    s_mov_b64 exec, -1
    s_branch B_join
B_heavy:
    s_waitcnt vmcnt(1)
    v_lshlrev_b32 v14, 16, v14
    v_lshlrev_b32 v15, 16, v15
    s_mov_b32 s50, 0x3fb8aa3b
    v_mul_f32 v14, s50, v14
    v_exp_f32 v14, v14
    s_mov_b32 s6, 0x7fff7fff
    v_and_b32 v3, s6, v12
    v_and_b32 v5, s6, v13
    v_pk_max_u16 v3, v3, v5
    v_lshrrev_b32 v4, 16, v3
    v_and_b32 v3, 0xffff, v3
    v_max_u32 v3, v3, v4
    v_cvt_pk_bf16_f32 v14, v14, v14
    v_lshlrev_b32 v14, 16, v14
    v_max_u32_dpp v3, v3, v3 row_shr:1 row_mask:0xf bank_mask:0xf
    s_nop 1
    v_max_u32_dpp v3, v3, v3 row_shr:2 row_mask:0xf bank_mask:0xf
    s_nop 1
    v_max_u32_dpp v3, v3, v3 row_shr:4 row_mask:0xf bank_mask:0xf
    s_nop 1
    v_max_u32_dpp v3, v3, v3 row_shr:8 row_mask:0xf bank_mask:0xf
    s_nop 1
    v_max_u32_dpp v3, v3, v3 row_bcast:15 row_mask:0xa bank_mask:0xf
    s_nop 1
    v_max_u32_dpp v3, v3, v3 row_bcast:31 row_mask:0xc bank_mask:0xf
    v_mul_f32 v16, 0xbfb8aa3b, v14
    v_mul_f32 v17, 0.15915494, v14
    v_readlane_b32 s6, v3, 63
    s_nop 0
    s_lshr_b32 s6, s6, 7
    s_sub_u32 s13, 136, s6
    s_mov_b32 m0, s14
    v_mov_b32 v3, 0x3c00
    ds_write_addtid_b32 v3 offset:0
    v_mov_b32 v20, 0
    v_mov_b32 v21, 0
    v_mov_b32 v22, 0
    v_mov_b32 v23, 0
    v_mov_b32 v24, 0
    v_mov_b32 v25, 0
    v_mov_b32 v26, 0
    v_mov_b32 v27, 0
    v_mov_b32 v28, 0
    v_mov_b32 v29, 0
    v_mov_b32 v30, 0
    v_mov_b32 v31, 0
    s_mov_b32 s77, 0
    s_mov_b32 s78, 0x41000000
    s_mov_b32 s79, 0x43000000
KG_loop:
    v_lshlrev_b32 v3, 16, v10
    v_lshrrev_b32 v10, 16, v10
    v_lshlrev_b32 v4, 16, v11
    v_lshrrev_b32 v11, 16, v11
    v_lshlrev_b32 v5, 16, v12
    v_lshrrev_b32 v12, 16, v12
    v_lshlrev_b32 v6, 16, v13
    v_lshrrev_b32 v13, 16, v13
    v_mul_f32 v3, s50, v3
    v_exp_f32 v3, v3
    v_mul_f32 v4, v4, v17
    v_ldexp_f32 v60, v5, s13
    v_ldexp_f32 v61, v6, s13
    v_cvt_pk_bf16_f32 v3, v3, v3
    v_lshlrev_b32 v3, 16, v3
    v_mul_f32 v3, v3, v16
    v_mul_f32 v90, s78, v4
    v_mul_f32 v91, s79, v4
    v_fract_f32 v89, v4
    v_fract_f32 v90, v90
    v_fract_f32 v91, v91
    v_mul_f32 v87, s78, v3
    v_mul_f32 v88, s79, v3
    v_cos_f32 v32, v89
    v_sin_f32 v33, v89
    v_cos_f32 v38, v90
    v_sin_f32 v39, v90
    v_cos_f32 v50, v91
    v_sin_f32 v51, v91
    v_exp_f32 v86, v3
    v_exp_f32 v87, v87
    v_exp_f32 v88, v88
    v_cvt_pk_f16_f32 v107, v60, v61
    v_mul_f32 v32, v32, v86
    v_mul_f32 v33, v33, v86
    v_mul_f32 v38, v38, v87
    v_mul_f32 v39, v39, v87
    v_mul_f32 v50, v50, v88
    v_mul_f32 v51, v51, v88
    v_pk_mul_f32 v[86:87], v[38:39], v[38:39] op_sel:[0,0] op_sel_hi:[0,1]
    v_pk_mul_f32 v[88:89], v[50:51], v[50:51] op_sel:[0,0] op_sel_hi:[0,1]
    v_pk_mul_f32 v[90:91], v[60:61], v[32:33] op_sel:[0,0] op_sel_hi:[0,1]
    v_pk_mul_f32 v[92:93], v[32:33], v[32:33] op_sel:[0,0] op_sel_hi:[0,1]
    v_pk_fma_f32 v[40:41], v[38:39], v[38:39], v[86:87] op_sel:[1,1,0] op_sel_hi:[1,0,1] neg_lo:[1,0,0]
    v_pk_fma_f32 v[52:53], v[50:51], v[50:51], v[88:89] op_sel:[1,1,0] op_sel_hi:[1,0,1] neg_lo:[1,0,0]
    v_pk_fma_f32 v[62:63], v[60:61], v[32:33], v[90:91] op_sel:[1,1,0] op_sel_hi:[1,0,1] neg_lo:[1,0,0]
    v_pk_fma_f32 v[34:35], v[32:33], v[32:33], v[92:93] op_sel:[1,1,0] op_sel_hi:[1,0,1] neg_lo:[1,0,0]
    s_cmp_lg_u32 s77, 0
    s_cbranch_scc1 nopub_21
    s_waitcnt vmcnt(0)
    s_barrier
    s_cmp_lg_u32 s5, 7
    s_cbranch_scc1 nopub_21
    v_mov_b32 v3, s51
    v_mov_b32 v8, 1
    s_mov_b64 exec, 1
    buffer_atomic_add v8, v3, s[64:67], 0 offen sc0 sc1
    s_mov_b64 exec, -1
nopub_21:
    v_cvt_pk_f16_f32 v98, v38, -v39
    v_cvt_pk_f16_f32 v104, v50, v51
    ds_write_addtid_b32 v98 offset:288
    v_pk_mul_f32 v[86:87], v[40:41], v[40:41] op_sel:[0,0] op_sel_hi:[0,1]
    v_pk_mul_f32 v[88:89], v[52:53], v[52:53] op_sel:[0,0] op_sel_hi:[0,1]
    v_pk_mul_f32 v[90:91], v[62:63], v[32:33] op_sel:[0,0] op_sel_hi:[0,1]
    v_pk_mul_f32 v[92:93], v[62:63], v[34:35] op_sel:[0,0] op_sel_hi:[0,1]
    v_pk_mul_f32 v[94:95], v[34:35], v[34:35] op_sel:[0,0] op_sel_hi:[0,1]
    v_pk_mul_f32 v[96:97], v[38:39], v[40:41] op_sel:[0,0] op_sel_hi:[0,1]
    v_pk_fma_f32 v[42:43], v[40:41], v[40:41], v[86:87] op_sel:[1,1,0] op_sel_hi:[1,0,1] neg_lo:[1,0,0]
    v_pk_fma_f32 v[54:55], v[52:53], v[52:53], v[88:89] op_sel:[1,1,0] op_sel_hi:[1,0,1] neg_lo:[1,0,0]
    v_pk_fma_f32 v[64:65], v[62:63], v[32:33], v[90:91] op_sel:[1,1,0] op_sel_hi:[1,0,1] neg_lo:[1,0,0]
    v_pk_fma_f32 v[66:67], v[62:63], v[34:35], v[92:93] op_sel:[1,1,0] op_sel_hi:[1,0,1] neg_lo:[1,0,0]
    v_pk_fma_f32 v[36:37], v[34:35], v[34:35], v[94:95] op_sel:[1,1,0] op_sel_hi:[1,0,1] neg_lo:[1,0,0]
    v_pk_fma_f32 v[46:47], v[38:39], v[40:41], v[96:97] op_sel:[1,1,0] op_sel_hi:[1,0,1] neg_lo:[1,0,0]
    v_cvt_pk_f16_f32 v99, v40, -v41
    v_cvt_pk_f16_f32 v105, v52, v53
    v_cvt_pk_f16_f32 v108, v62, v63
    ds_write_addtid_b32 v99 offset:576
    ds_write_addtid_b32 v108 offset:4608
    v_pk_mul_f32 v[86:87], v[42:43], v[42:43] op_sel:[0,0] op_sel_hi:[0,1]
    v_pk_mul_f32 v[88:89], v[54:55], v[54:55] op_sel:[0,0] op_sel_hi:[0,1]
    v_pk_mul_f32 v[90:91], v[64:65], v[34:35] op_sel:[0,0] op_sel_hi:[0,1]
    v_pk_mul_f32 v[92:93], v[50:51], v[52:53] op_sel:[0,0] op_sel_hi:[0,1]
    v_pk_mul_f32 v[94:95], v[62:63], v[36:37] op_sel:[0,0] op_sel_hi:[0,1]
    v_pk_mul_f32 v[96:97], v[64:65], v[36:37] op_sel:[0,0] op_sel_hi:[0,1]
    v_pk_fma_f32 v[44:45], v[42:43], v[42:43], v[86:87] op_sel:[1,1,0] op_sel_hi:[1,0,1] neg_lo:[1,0,0]
    v_pk_fma_f32 v[56:57], v[54:55], v[54:55], v[88:89] op_sel:[1,1,0] op_sel_hi:[1,0,1] neg_lo:[1,0,0]
    v_pk_fma_f32 v[68:69], v[64:65], v[34:35], v[90:91] op_sel:[1,1,0] op_sel_hi:[1,0,1] neg_lo:[1,0,0]
    v_pk_fma_f32 v[58:59], v[50:51], v[52:53], v[92:93] op_sel:[1,1,0] op_sel_hi:[1,0,1] neg_lo:[1,0,0]
    v_pk_fma_f32 v[70:71], v[62:63], v[36:37], v[94:95] op_sel:[1,1,0] op_sel_hi:[1,0,1] neg_lo:[1,0,0]
    v_pk_fma_f32 v[72:73], v[64:65], v[36:37], v[96:97] op_sel:[1,1,0] op_sel_hi:[1,0,1] neg_lo:[1,0,0]
    v_cvt_pk_f16_f32 v101, v42, -v43
    v_cvt_pk_f16_f32 v100, v46, -v47
    v_cvt_pk_f16_f32 v109, v64, v65
    v_cvt_pk_f16_f32 v110, v66, v67
    ds_write_addtid_b32 v101 offset:1152
    ds_write_addtid_b32 v100 offset:864
    ds_write_addtid_b32 v109 offset:4896
    ds_write_addtid_b32 v110 offset:5184
    v_pk_mul_f32 v[86:87], v[42:43], v[44:45] op_sel:[0,0] op_sel_hi:[0,1]
    v_pk_mul_f32 v[88:89], v[66:67], v[36:37] op_sel:[0,0] op_sel_hi:[0,1]
    v_pk_mul_f32 v[90:91], v[68:69], v[36:37] op_sel:[0,0] op_sel_hi:[0,1]
    v_pk_mul_f32 v[92:93], v[68:69], v[54:55] op_sel:[0,0] op_sel_hi:[0,1]
    v_pk_fma_f32 v[48:49], v[42:43], v[44:45], v[86:87] op_sel:[1,1,0] op_sel_hi:[1,0,1] neg_lo:[1,0,0]
    v_pk_fma_f32 v[74:75], v[66:67], v[36:37], v[88:89] op_sel:[1,1,0] op_sel_hi:[1,0,1] neg_lo:[1,0,0]
    v_pk_fma_f32 v[76:77], v[68:69], v[36:37], v[90:91] op_sel:[1,1,0] op_sel_hi:[1,0,1] neg_lo:[1,0,0]
    v_pk_fma_f32 v[78:79], v[68:69], v[54:55], v[92:93] op_sel:[1,1,0] op_sel_hi:[1,0,1] neg_lo:[1,0,0]
    v_cvt_pk_f16_f32 v102, v44, -v45
    v_cvt_pk_f16_f32 v106, v58, v59
    v_cvt_pk_f16_f32 v111, v68, v69
    v_cvt_pk_f16_f32 v112, v70, v71
    v_cvt_pk_f16_f32 v113, v72, v73
    ds_write_addtid_b32 v102 offset:2304
    ds_write_addtid_b32 v111 offset:5472
    ds_write_addtid_b32 v112 offset:5760
    ds_write_addtid_b32 v113 offset:6048
    v_pk_mul_f32 v[86:87], v[76:77], v[54:55] op_sel:[0,0] op_sel_hi:[0,1]
    v_pk_mul_f32 v[88:89], v[76:77], v[56:57] op_sel:[0,0] op_sel_hi:[0,1]
    v_pk_fma_f32 v[80:81], v[76:77], v[54:55], v[86:87] op_sel:[1,1,0] op_sel_hi:[1,0,1] neg_lo:[1,0,0]
    v_pk_fma_f32 v[82:83], v[76:77], v[56:57], v[88:89] op_sel:[1,1,0] op_sel_hi:[1,0,1] neg_lo:[1,0,0]
    v_cvt_pk_f16_f32 v103, v48, -v49
    v_cvt_pk_f16_f32 v114, v74, v75
    v_cvt_pk_f16_f32 v115, v76, v77
    v_cvt_pk_f16_f32 v116, v78, v79
    ds_write_addtid_b32 v103 offset:3456
    ds_write_addtid_b32 v114 offset:6336
    ds_write_addtid_b32 v115 offset:6624
    v_pk_mul_f32 v[86:87], v[80:81], v[56:57] op_sel:[0,0] op_sel_hi:[0,1]
    v_pk_fma_f32 v[84:85], v[80:81], v[56:57], v[86:87] op_sel:[1,1,0] op_sel_hi:[1,0,1] neg_lo:[1,0,0]
    v_cvt_pk_f16_f32 v117, v80, v81
    v_cvt_pk_f16_f32 v118, v82, v83
    v_pk_mul_f16 v32, v98, v101 op_sel:[0,0] op_sel_hi:[0,1]
    v_cvt_pk_f16_f32 v119, v84, v85
    v_pk_mul_f16 v33, v99, v101 op_sel:[0,0] op_sel_hi:[0,1]
    v_pk_mul_f16 v34, v100, v101 op_sel:[0,0] op_sel_hi:[0,1]
    v_pk_fma_f16 v40, v98, v101, v32 op_sel:[1,1,0] op_sel_hi:[1,0,1] neg_lo:[1,0,0]
    v_pk_mul_f16 v35, v98, v102 op_sel:[0,0] op_sel_hi:[0,1]
    v_pk_fma_f16 v41, v99, v101, v33 op_sel:[1,1,0] op_sel_hi:[1,0,1] neg_lo:[1,0,0]
    v_pk_mul_f16 v36, v99, v102 op_sel:[0,0] op_sel_hi:[0,1]
    v_pk_fma_f16 v42, v100, v101, v34 op_sel:[1,1,0] op_sel_hi:[1,0,1] neg_lo:[1,0,0]
    s_waitcnt lgkmcnt(12)
    ds_write_addtid_b32 v40 offset:1440
    v_pk_mul_f16 v37, v100, v102 op_sel:[0,0] op_sel_hi:[0,1]
    v_pk_fma_f16 v43, v98, v102, v35 op_sel:[1,1,0] op_sel_hi:[1,0,1] neg_lo:[1,0,0]
    ds_write_addtid_b32 v41 offset:1728
    v_pk_mul_f16 v38, v98, v103 op_sel:[0,0] op_sel_hi:[0,1]
    v_pk_fma_f16 v44, v99, v102, v36 op_sel:[1,1,0] op_sel_hi:[1,0,1] neg_lo:[1,0,0]
    ds_write_addtid_b32 v42 offset:2016
    v_pk_mul_f16 v39, v99, v103 op_sel:[0,0] op_sel_hi:[0,1]
    v_pk_fma_f16 v45, v100, v102, v37 op_sel:[1,1,0] op_sel_hi:[1,0,1] neg_lo:[1,0,0]
    s_waitcnt lgkmcnt(12)
    ds_write_addtid_b32 v43 offset:2592
    v_pk_mul_f16 v32, v100, v103 op_sel:[0,0] op_sel_hi:[0,1]
    v_pk_fma_f16 v46, v98, v103, v38 op_sel:[1,1,0] op_sel_hi:[1,0,1] neg_lo:[1,0,0]
    ds_write_addtid_b32 v44 offset:2880
    v_pk_mul_f16 v33, v108, v104 op_sel:[0,0] op_sel_hi:[0,1]
    v_pk_fma_f16 v47, v99, v103, v39 op_sel:[1,1,0] op_sel_hi:[1,0,1] neg_lo:[1,0,0]
    ds_write_addtid_b32 v45 offset:3168
    v_pk_mul_f16 v34, v109, v104 op_sel:[0,0] op_sel_hi:[0,1]
    v_pk_fma_f16 v40, v100, v103, v32 op_sel:[1,1,0] op_sel_hi:[1,0,1] neg_lo:[1,0,0]
    s_waitcnt lgkmcnt(12)
    ds_write_addtid_b32 v46 offset:3744
    v_pk_mul_f16 v35, v110, v104 op_sel:[0,0] op_sel_hi:[0,1]
    v_pk_fma_f16 v41, v108, v104, v33 op_sel:[1,1,0] op_sel_hi:[1,0,1] neg_lo:[1,0,0]
    ds_write_addtid_b32 v47 offset:4032
    v_pk_mul_f16 v36, v111, v104 op_sel:[0,0] op_sel_hi:[0,1]
    v_pk_fma_f16 v42, v109, v104, v34 op_sel:[1,1,0] op_sel_hi:[1,0,1] neg_lo:[1,0,0]
    ds_write_addtid_b32 v40 offset:4320
    v_pk_mul_f16 v37, v112, v104 op_sel:[0,0] op_sel_hi:[0,1]
    v_pk_fma_f16 v43, v110, v104, v35 op_sel:[1,1,0] op_sel_hi:[1,0,1] neg_lo:[1,0,0]
    s_waitcnt lgkmcnt(12)
    ds_write_addtid_b32 v41 offset:6912
    v_pk_mul_f16 v38, v113, v104 op_sel:[0,0] op_sel_hi:[0,1]
    v_pk_fma_f16 v44, v111, v104, v36 op_sel:[1,1,0] op_sel_hi:[1,0,1] neg_lo:[1,0,0]
    ds_write_addtid_b32 v42 offset:7200
    v_pk_mul_f16 v39, v114, v104 op_sel:[0,0] op_sel_hi:[0,1]
    v_pk_fma_f16 v45, v112, v104, v37 op_sel:[1,1,0] op_sel_hi:[1,0,1] neg_lo:[1,0,0]
    ds_write_addtid_b32 v43 offset:7488
    v_pk_mul_f16 v32, v115, v104 op_sel:[0,0] op_sel_hi:[0,1]
    v_pk_fma_f16 v46, v113, v104, v38 op_sel:[1,1,0] op_sel_hi:[1,0,1] neg_lo:[1,0,0]
    s_waitcnt lgkmcnt(12)
    ds_write_addtid_b32 v44 offset:7776
    v_pk_fma_f16 v47, v114, v104, v39 op_sel:[1,1,0] op_sel_hi:[1,0,1] neg_lo:[1,0,0]
    ds_write_addtid_b32 v45 offset:8064
    v_pk_fma_f16 v40, v115, v104, v32 op_sel:[1,1,0] op_sel_hi:[1,0,1] neg_lo:[1,0,0]
    ds_write_addtid_b32 v46 offset:8352
    s_waitcnt lgkmcnt(12)
    ds_write_addtid_b32 v47 offset:8640
    ds_write_addtid_b32 v40 offset:8928
    ds_read_b128 v[60:63], v18 offset:0
    s_waitcnt lgkmcnt(12)
    ds_read_b128 v[76:79], v18 offset:4608
    ds_read_b128 v[64:67], v18 offset:64
    ds_read_b128 v[80:83], v18 offset:4672
    s_waitcnt lgkmcnt(12)
    ds_read_b128 v[68:71], v18 offset:128
    ds_read_b128 v[84:87], v18 offset:4736
    ds_read_b128 v[72:75], v18 offset:192
    s_waitcnt lgkmcnt(12)
    ds_read_b128 v[88:91], v18 offset:4800
    ds_write_addtid_b32 v116 offset:2592
    ds_write_addtid_b32 v117 offset:2880
    s_waitcnt lgkmcnt(12)
    ds_write_addtid_b32 v118 offset:4896
    ds_write_addtid_b32 v119 offset:6048
    ds_write_addtid_b32 v107 offset:7200
    v_pk_mul_f16 v32, v109, v105 op_sel:[0,0] op_sel_hi:[0,1]
    v_pk_mul_f16 v33, v111, v105 op_sel:[0,0] op_sel_hi:[0,1]
    v_pk_mul_f16 v34, v113, v105 op_sel:[0,0] op_sel_hi:[0,1]
    v_pk_fma_f16 v40, v109, v105, v32 op_sel:[1,1,0] op_sel_hi:[1,0,1] neg_lo:[1,0,0]
    v_pk_mul_f16 v35, v115, v105 op_sel:[0,0] op_sel_hi:[0,1]
    v_pk_fma_f16 v41, v111, v105, v33 op_sel:[1,1,0] op_sel_hi:[1,0,1] neg_lo:[1,0,0]
    v_pk_mul_f16 v36, v109, v106 op_sel:[0,0] op_sel_hi:[0,1]
    v_pk_fma_f16 v42, v113, v105, v34 op_sel:[1,1,0] op_sel_hi:[1,0,1] neg_lo:[1,0,0]
    s_waitcnt lgkmcnt(12)
    ds_write_addtid_b32 v40 offset:288
    v_pk_mul_f16 v37, v111, v106 op_sel:[0,0] op_sel_hi:[0,1]
    v_pk_fma_f16 v43, v115, v105, v35 op_sel:[1,1,0] op_sel_hi:[1,0,1] neg_lo:[1,0,0]
    ds_write_addtid_b32 v41 offset:576
    v_pk_mul_f16 v38, v113, v106 op_sel:[0,0] op_sel_hi:[0,1]
    v_pk_fma_f16 v44, v109, v106, v36 op_sel:[1,1,0] op_sel_hi:[1,0,1] neg_lo:[1,0,0]
    ds_write_addtid_b32 v42 offset:864
    v_pk_mul_f16 v39, v115, v106 op_sel:[0,0] op_sel_hi:[0,1]
    v_pk_fma_f16 v45, v111, v106, v37 op_sel:[1,1,0] op_sel_hi:[1,0,1] neg_lo:[1,0,0]
    s_waitcnt lgkmcnt(12)
    ds_write_addtid_b32 v43 offset:1152
    v_pk_fma_f16 v46, v113, v106, v38 op_sel:[1,1,0] op_sel_hi:[1,0,1] neg_lo:[1,0,0]
    ds_write_addtid_b32 v44 offset:1440
    v_pk_fma_f16 v47, v115, v106, v39 op_sel:[1,1,0] op_sel_hi:[1,0,1] neg_lo:[1,0,0]
    ds_write_addtid_b32 v45 offset:1728
    s_waitcnt lgkmcnt(12)
    ds_write_addtid_b32 v46 offset:2016
    ds_write_addtid_b32 v47 offset:2304
    s_cmp_lg_u32 s77, 0
    s_cbranch_scc1 chk1_22
    s_cmp_lg_u32 s5, 7
    s_cbranch_scc1 chk2_23
    s_waitcnt vmcnt(0)
    v_readfirstlane_b32 s7, v8
    s_nop 0
    s_cmp_lg_u32 s7, 31
    s_cbranch_scc1 chk2_23
    v_lshlrev_b32 v3, 7, v7
    v_mov_b32 v4, 1
    s_lshl_b32 s6, s9, 12
    s_add_u32 s6, s6, 65536
    s_mov_b64 exec, 0xffffffff
    buffer_atomic_add v4, v3, s[72:75], s6 offen sc1
    s_mov_b64 exec, -1
    s_branch chk2_23
chk1_22:
    buffer_load_dword v8, v9, s[72:75], 0 offen sc1
chk2_23:
    s_waitcnt lgkmcnt(8)
    v_pk_mul_f16 v32, v116, v104 op_sel:[0,0] op_sel_hi:[0,1]
    v_mfma_f32_16x16x32_f16 v[20:23], v[76:79], v[60:63], v[20:23]
    v_pk_mul_f16 v33, v116, v105 op_sel:[0,0] op_sel_hi:[0,1]
    s_nop 0
    v_pk_mul_f16 v34, v116, v106 op_sel:[0,0] op_sel_hi:[0,1]
    v_pk_fma_f16 v40, v116, v104, v32 op_sel:[1,1,0] op_sel_hi:[1,0,1] neg_lo:[1,0,0]
    v_mfma_f32_16x16x32_f16 v[20:23], v[80:83], v[64:67], v[20:23]
    v_pk_mul_f16 v35, v117, v104 op_sel:[0,0] op_sel_hi:[0,1]
    v_pk_fma_f16 v41, v116, v105, v33 op_sel:[1,1,0] op_sel_hi:[1,0,1] neg_lo:[1,0,0]
    s_nop 0
    v_pk_mul_f16 v36, v117, v105 op_sel:[0,0] op_sel_hi:[0,1]
    v_pk_fma_f16 v42, v116, v106, v34 op_sel:[1,1,0] op_sel_hi:[1,0,1] neg_lo:[1,0,0]
    ds_write_addtid_b32 v40 offset:3168
    v_mfma_f32_16x16x32_f16 v[20:23], v[84:87], v[68:71], v[20:23]
    v_pk_mul_f16 v37, v117, v106 op_sel:[0,0] op_sel_hi:[0,1]
    v_pk_fma_f16 v43, v117, v104, v35 op_sel:[1,1,0] op_sel_hi:[1,0,1] neg_lo:[1,0,0]
    ds_write_addtid_b32 v41 offset:3744
    s_nop 0
    v_pk_mul_f16 v38, v118, v104 op_sel:[0,0] op_sel_hi:[0,1]
    v_pk_fma_f16 v44, v117, v105, v36 op_sel:[1,1,0] op_sel_hi:[1,0,1] neg_lo:[1,0,0]
    ds_write_addtid_b32 v42 offset:4320
    v_mfma_f32_16x16x32_f16 v[20:23], v[88:91], v[72:75], v[20:23]
    v_pk_mul_f16 v39, v118, v105 op_sel:[0,0] op_sel_hi:[0,1]
    v_pk_fma_f16 v45, v117, v106, v37 op_sel:[1,1,0] op_sel_hi:[1,0,1] neg_lo:[1,0,0]
    ds_write_addtid_b32 v43 offset:3456
    v_pk_mul_f16 v32, v118, v106 op_sel:[0,0] op_sel_hi:[0,1]
    v_pk_fma_f16 v46, v118, v104, v38 op_sel:[1,1,0] op_sel_hi:[1,0,1] neg_lo:[1,0,0]
    ds_write_addtid_b32 v44 offset:4032
    v_pk_mul_f16 v33, v119, v104 op_sel:[0,0] op_sel_hi:[0,1]
    v_pk_fma_f16 v47, v118, v105, v39 op_sel:[1,1,0] op_sel_hi:[1,0,1] neg_lo:[1,0,0]
    ds_write_addtid_b32 v45 offset:4608
    v_pk_mul_f16 v34, v119, v105 op_sel:[0,0] op_sel_hi:[0,1]
    v_pk_fma_f16 v40, v118, v106, v32 op_sel:[1,1,0] op_sel_hi:[1,0,1] neg_lo:[1,0,0]
    ds_write_addtid_b32 v46 offset:5184
    v_pk_mul_f16 v35, v119, v106 op_sel:[0,0] op_sel_hi:[0,1]
    v_pk_fma_f16 v41, v119, v104, v33 op_sel:[1,1,0] op_sel_hi:[1,0,1] neg_lo:[1,0,0]
    s_waitcnt lgkmcnt(12)
    ds_write_addtid_b32 v47 offset:5472
    v_pk_fma_f16 v42, v119, v105, v34 op_sel:[1,1,0] op_sel_hi:[1,0,1] neg_lo:[1,0,0]
    ds_write_addtid_b32 v40 offset:5760
    v_pk_fma_f16 v43, v119, v106, v35 op_sel:[1,1,0] op_sel_hi:[1,0,1] neg_lo:[1,0,0]
    ds_write_addtid_b32 v41 offset:6336
    s_waitcnt lgkmcnt(12)
    ds_write_addtid_b32 v42 offset:6624
    ds_write_addtid_b32 v43 offset:6912
    ds_read_b128 v[76:79], v18 offset:288
    s_waitcnt lgkmcnt(12)
    ds_read_b128 v[32:35], v19 offset:4896
    ds_read_b128 v[80:83], v18 offset:352
    ds_read_b128 v[36:39], v19 offset:4960
    s_waitcnt lgkmcnt(12)
    ds_read_b128 v[84:87], v18 offset:416
    ds_read_b128 v[40:43], v19 offset:5024
    ds_read_b128 v[88:91], v18 offset:480
    s_waitcnt lgkmcnt(12)
    ds_read_b128 v[44:47], v19 offset:5088
    s_waitcnt lgkmcnt(6)
    v_mfma_f32_16x16x32_f16 v[24:27], v[76:79], v[60:63], v[24:27]
    v_mfma_f32_16x16x32_f16 v[28:31], v[32:35], v[60:63], v[28:31]
    s_waitcnt lgkmcnt(4)
    v_mfma_f32_16x16x32_f16 v[24:27], v[80:83], v[64:67], v[24:27]
    v_mfma_f32_16x16x32_f16 v[28:31], v[36:39], v[64:67], v[28:31]
    s_waitcnt lgkmcnt(2)
    v_mfma_f32_16x16x32_f16 v[24:27], v[84:87], v[68:71], v[24:27]
    v_mfma_f32_16x16x32_f16 v[28:31], v[40:43], v[68:71], v[28:31]
    s_waitcnt lgkmcnt(0)
    v_mfma_f32_16x16x32_f16 v[24:27], v[88:91], v[72:75], v[24:27]
    v_mfma_f32_16x16x32_f16 v[28:31], v[44:47], v[72:75], v[28:31]
    s_add_u32 s77, s77, 1
    s_cmp_lt_u32 s77, 2
    s_cbranch_scc1 KG_loop
    s_waitcnt vmcnt(0)
    v_readfirstlane_b32 s6, v8
    s_nop 0
    s_cmp_lg_u32 s6, s42
    s_cbranch_scc1 bw_24
    s_mov_b32 s6, 0
    v_mov_b32 v3, s100
    s_mov_b64 exec, 1
poll_25:
    buffer_load_dword v4, v3, s[72:75], 0 offen offset:0 sc1
    s_add_u32 s6, s6, 1
    s_waitcnt vmcnt(0)
    v_cmp_ne_u32 vcc, s42, v4
    s_cbranch_vccnz polld_26
    s_sleep 2
    s_cmp_lt_u32 s6, 0x10000
    s_cbranch_scc1 poll_25
polld_26:
    s_mov_b64 exec, -1
bw_24:
    v_lshlrev_b32 v8, 4, v7
    s_lshl_b32 s6, s12, 12
    s_lshl_b32 s7, s49, 11
    s_add_u32 s6, s6, s7
    buffer_load_dwordx4 v[120:123], v8, s[52:55], s6 offen offset:0 sc1
    buffer_load_dwordx4 v[124:127], v8, s[52:55], s6 offen offset:1024 sc1
    v_add_f32 v14, v14, v14
    s_sub_u32 s7, 0, s13
    v_mul_f32 v20, v20, v14
    v_mul_f32 v21, v21, v14
    v_mul_f32 v22, v22, v14
    v_mul_f32 v23, v23, v14
    v_mul_f32 v24, v24, v14
    v_mul_f32 v25, v25, v14
    v_mul_f32 v26, v26, v14
    v_mul_f32 v27, v27, v14
    v_mul_f32 v28, v28, v14
    v_mul_f32 v29, v29, v14
    v_mul_f32 v30, v30, v14
    v_mul_f32 v31, v31, v14
    v_ldexp_f32 v20, v20, s7
    v_ldexp_f32 v21, v21, s7
    v_ldexp_f32 v22, v22, s7
    v_ldexp_f32 v23, v23, s7
    v_ldexp_f32 v24, v24, s7
    v_ldexp_f32 v25, v25, s7
    v_ldexp_f32 v26, v26, s7
    v_ldexp_f32 v27, v27, s7
    v_ldexp_f32 v28, v28, s7
    v_ldexp_f32 v29, v29, s7
    v_ldexp_f32 v30, v30, s7
    v_ldexp_f32 v31, v31, s7
    v_add_u32 v3, s14, v8
    ds_write_b128 v3, v[20:23] offset:0
    ds_write_b128 v3, v[24:27] offset:1024
    ds_write_b128 v3, v[28:31] offset:2048
    s_xor_b32 s6, s5, 4
    s_mul_i32 s6, s6, 9216
    v_add_u32 v3, s6, v8
    s_lshl_b32 s6, s48, 11
    s_add_u32 s59, s6, 73728
    v_cmp_le_u32 vcc, 2, v2
    s_waitcnt lgkmcnt(0)
    s_barrier
    s_cmp_lg_u32 s49, 0
    s_cbranch_scc1 own2_27
    ds_read_b128 v[32:35], v3 offset:0
    ds_read_b128 v[36:39], v3 offset:1024
    v_lshrrev_b32 v3, 1, v2
    v_lshlrev_b32 v3, 8, v3
    v_lshl_add_u32 v3, v1, 4, v3
    v_and_b32 v4, 1, v2
    v_lshl_add_u32 v3, v4, 3, v3
    v_add_u32 v44, s59, v3
    v_lshlrev_b32 v3, 7, v2
    v_lshl_add_u32 v3, v1, 3, v3
    v_add_u32 v3, 528, v3
    v_add_u32 v4, 4, v3
    v_lshlrev_b32 v5, 7, v2
    v_lshl_add_u32 v5, v1, 2, v5
    v_add_u32 v5, 528, v5
    v_add_u32 v6, 64, v5
    v_cndmask_b32 v3, v3, v5, vcc
    v_cndmask_b32 v4, v4, v6, vcc
    v_add_u32 v3, s59, v3
    v_add_u32 v4, s59, v4
    s_waitcnt lgkmcnt(0)
    v_pk_add_f32 v[32:33], v[32:33], v[20:21]
    v_pk_add_f32 v[34:35], v[34:35], v[22:23]
    v_pk_add_f32 v[36:37], v[36:37], v[24:25]
    v_pk_add_f32 v[38:39], v[38:39], v[26:27]
    v_cvt_pk_bf16_f32 v40, v32, v33
    v_cvt_pk_bf16_f32 v41, v34, v35
    v_cvt_pk_bf16_f32 v42, v36, v37
    v_cvt_pk_bf16_f32 v43, v38, v39
    ds_write_b64 v44, v[40:41] offset:16
    ds_write_b32 v3, v42
    ds_write_b32 v4, v43
    s_branch ownj_28
own2_27:
    ds_read_b128 v[32:35], v3 offset:2048
    v_mov_b32 v3, 0
    v_cndmask_b32 v3, v3, v15, vcc
    v_add_f32 v28, v28, v3
    v_lshlrev_b32 v3, 7, v2
    v_lshl_add_u32 v3, v1, 1, v3
    v_add_u32 v3, 1040, v3
    v_cmp_eq_u32 vcc, 32, v7
    v_mov_b32 v5, 14
    s_nop 0
    v_cndmask_b32 v4, v3, v5, vcc
    v_add_u32 v3, s59, v3
    v_add_u32 v4, s59, v4
    s_waitcnt lgkmcnt(0)
    v_pk_add_f32 v[32:33], v[32:33], v[28:29]
    v_pk_add_f32 v[34:35], v[34:35], v[30:31]
    v_cvt_pk_bf16_f32 v36, v32, v33
    v_cvt_pk_bf16_f32 v37, v34, v35
    s_mov_b32 s6, -1
    s_mov_b32 s7, 1
    s_mov_b64 exec, s[6:7]
    ds_write_b16 v4, v36
    s_mov_b64 exec, 0xffffffff
    ds_write_b16_d16_hi v3, v36 offset:32
    ds_write_b16 v3, v37 offset:64
    ds_write_b16_d16_hi v3, v37 offset:96
    s_mov_b64 exec, -1
ownj_28:
    s_waitcnt lgkmcnt(0)
    s_barrier
    s_cmp_eq_u32 s49, 0
    s_cbranch_scc1 npub_29
    v_add_u32 v3, s59, v8
    ds_read_b128 v[32:35], v3
    ds_read_b128 v[36:39], v3 offset:1024
    s_lshl_b32 s6, s12, 12
    s_waitcnt lgkmcnt(0)
    buffer_store_dwordx4 v[32:35], v8, s[68:71], s6 offen sc1
    s_mov_b64 exec, 1
    buffer_store_dwordx4 v[36:39], v8, s[68:71], s6 offen offset:1024 sc1
    s_mov_b64 exec, -1
    s_waitcnt vmcnt(0)
    s_xor_b32 s6, s100, 128
    v_mov_b32 v3, s6
    v_mov_b32 v4, 1
    s_mov_b64 exec, 1
    buffer_atomic_add v4, v3, s[72:75], 0 offen offset:4 sc1
    s_mov_b64 exec, -1
npub_29:
    s_branch B_join2
B_join:
    s_nop 3
    s_setprio 0
    s_mov_b32 s6, 0
    v_mov_b32 v3, s100
    s_mov_b64 exec, 1
poll_31:
    buffer_load_dword v4, v3, s[72:75], 0 offen offset:0 sc1
    s_add_u32 s6, s6, 1
    s_waitcnt vmcnt(0)
    v_cmp_ne_u32 vcc, s42, v4
    s_cbranch_vccnz polld_32
    s_sleep 2
    s_cmp_lt_u32 s6, 0x10000
    s_cbranch_scc1 poll_31
polld_32:
    s_mov_b64 exec, -1
bw_30:
    v_lshlrev_b32 v8, 4, v7
    s_lshl_b32 s6, s12, 12
    s_lshl_b32 s7, s49, 11
    s_add_u32 s6, s6, s7
    buffer_load_dwordx4 v[120:123], v8, s[52:55], s6 offen offset:0 sc1
    buffer_load_dwordx4 v[124:127], v8, s[52:55], s6 offen offset:1024 sc1
B_join2:
    s_nop 3
    s_setprio 3
    s_lshl_b32 s14, s48, 14
    s_lshl_b32 s15, s48, 12
    s_add_u32 s15, s15, 65536
    v_lshrrev_b32 v4, 1, v8
    v_lshrrev_b32 v5, 2, v8
    v_lshrrev_b32 v6, 3, v8
    s_cmp_ge_u32 s4, 14
    s_cbranch_scc1 eown_33
    s_cmp_lg_u32 s49, 0
    s_cbranch_scc1 B_noexp
    s_mov_b32 s6, 0
    s_add_u32 s7, s43, 4
    s_mov_b64 exec, 1
pq_37:
    buffer_load_dword v3, v9, s[72:75], 0 offen offset:4 sc1
    s_add_u32 s6, s6, 1
    s_waitcnt vmcnt(0)
    v_cmp_eq_u32 vcc, s7, v3
    s_cbranch_vccnz pqd_38
    s_sleep 2
    s_cmp_lt_u32 s6, 0x10000
    s_cbranch_scc1 pq_37
pqd_38:
    s_mov_b64 exec, -1
    s_lshl_b32 s6, s12, 12
    buffer_load_dwordx4 v[32:35], v8, s[68:71], s6 offen offset:16 sc1
    buffer_load_dword v36, v8, s[68:71], s6 offen offset:12 sc1
    buffer_load_dwordx2 v[38:39], v4, s[68:71], s6 offen offset:272 sc1
    buffer_load_dword v37, v4, s[68:71], s6 offen offset:268 sc1
    buffer_load_dword v40, v5, s[68:71], s6 offen offset:784 sc1
    buffer_load_dword v41, v5, s[68:71], s6 offen offset:780 sc1
    s_branch erd_34
eown_33:
    v_add_u32 v3, s59, v8
    v_add_u32 v4, s59, v4
    v_add_u32 v5, s59, v5
    v_add_u32 v6, s59, v6
    s_cmp_lg_u32 s49, 0
    s_cbranch_scc1 eo1_35
    ds_read_b128 v[32:35], v3 offset:16
    ds_read_b32 v36, v3 offset:12
    ds_read_b64 v[38:39], v4 offset:272
    ds_read_b32 v37, v4 offset:268
    ds_read_b32 v40, v5 offset:784
    ds_read_b32 v41, v5 offset:780
    s_branch erd_34
eo1_35:
    ds_read_u16 v42, v6 offset:1038
    ds_read_u16 v43, v6 offset:1040
    ds_read_u16 v44, v6 offset:1166
    ds_read_u16 v45, v6 offset:1168
    ds_read_u16 v46, v6 offset:1036
erd_34:
    s_mov_b32 s6, 0xffff
    s_mov_b32 s7, 0x01000302
    s_mov_b32 s76, 0x03020302
    s_mov_b32 s77, 0x01000100
    v_and_b32 v3, 1, v7
    v_cmp_eq_u32 vcc, 1, v3
    s_waitcnt vmcnt(0) lgkmcnt(0)
    s_cmp_lg_u32 s49, 0
    s_cbranch_scc1 e1_39
    v_perm_b32 v48, v39, v39, s7
    v_perm_b32 v49, v38, v38, s76
    v_perm_b32 v50, v38, v38, s7
    v_perm_b32 v51, v37, v37, s76
    s_mov_b64 exec, 0xffffffff
    v_bfi_b32 v48, s6, v35, v34
    v_bfi_b32 v49, s6, v34, v33
    v_bfi_b32 v50, s6, v33, v32
    v_bfi_b32 v51, s6, v32, v36
    s_mov_b64 exec, -1
    v_perm_b32 v56, v40, v40, s76
    v_perm_b32 v57, v40, v40, s77
    v_bfi_b32 v58, s6, v40, v41
    v_perm_b32 v59, v41, v41, s76
    v_mov_b32 v10, 0
    v_mov_b32 v11, 0
    s_branch e2_40
e1_39:
    v_lshl_or_b32 v48, v43, 16, v43
    v_lshl_or_b32 v50, v42, 16, v42
    v_mov_b32 v51, v50
    v_cndmask_b32 v42, v42, v43, vcc
    v_lshl_or_b32 v49, v42, 16, v43
    v_lshl_or_b32 v56, v45, 16, v45
    v_lshl_or_b32 v58, v44, 16, v44
    v_mov_b32 v59, v58
    v_cndmask_b32 v44, v44, v45, vcc
    v_lshl_or_b32 v57, v44, 16, v45
    v_mov_b32 v10, v50
    v_lshl_or_b32 v11, v46, 16, v46
e2_40:
    v_sub_u32 v3, 1008, v8
    s_sub_u32 s6, 1, s49
    s_lshl_b32 s6, s6, 11
    s_add_u32 s6, s6, s14
    v_xor_b32 v4, 0, v3
    v_add_u32 v32, s6, v4
    v_xor_b32 v4, 64, v3
    v_add_u32 v33, s6, v4
    v_xor_b32 v4, 128, v3
    v_add_u32 v34, s6, v4
    v_xor_b32 v4, 192, v3
    v_add_u32 v35, s6, v4
    ds_write_b128 v32, v[48:51] offset:1024
    ds_write_b128 v32, v[56:59] offset:0
    ds_read_b64 v[52:53], v32 offset:1040
    ds_read_b64 v[60:61], v32 offset:16
    s_waitcnt lgkmcnt(0)
    s_mov_b64 exec, 1
    v_mov_b32 v52, v10
    v_mov_b32 v53, v11
    s_mov_b64 exec, -1
    v_alignbit_b32 v64, v49, v48, 16
    v_alignbit_b32 v65, v50, v49, 16
    v_alignbit_b32 v66, v51, v50, 16
    v_alignbit_b32 v67, v52, v51, 16
    ds_write_b128 v33, v[64:67] offset:5120
    v_mov_b32 v68, v49
    v_mov_b32 v69, v50
    v_mov_b32 v70, v51
    v_mov_b32 v71, v52
    ds_write_b128 v34, v[68:71] offset:9216
    v_alignbit_b32 v72, v50, v49, 16
    v_alignbit_b32 v73, v51, v50, 16
    v_alignbit_b32 v74, v52, v51, 16
    v_alignbit_b32 v75, v53, v52, 16
    ds_write_b128 v35, v[72:75] offset:13312
    v_alignbit_b32 v76, v57, v56, 16
    v_alignbit_b32 v77, v58, v57, 16
    v_alignbit_b32 v78, v59, v58, 16
    v_alignbit_b32 v79, v60, v59, 16
    ds_write_b128 v33, v[76:79] offset:4096
    v_mov_b32 v80, v57
    v_mov_b32 v81, v58
    v_mov_b32 v82, v59
    v_mov_b32 v83, v60
    ds_write_b128 v34, v[80:83] offset:8192
    v_alignbit_b32 v84, v58, v57, 16
    v_alignbit_b32 v85, v59, v58, 16
    v_alignbit_b32 v86, v60, v59, 16
    v_alignbit_b32 v87, v61, v60, 16
    ds_write_b128 v35, v[84:87] offset:12288
B_noexp:
    s_nop 1
    s_waitcnt vmcnt(0)
    s_barrier
    s_lshl_b32 s6, s49, 11
    s_add_u32 s6, s6, s15
    v_add_u32 v9, s6, v8
    ds_write_b128 v9, v[120:123] offset:0
    ds_write_b128 v9, v[124:127] offset:1024
    v_lshrrev_b32 v3, 2, v1
    v_and_b32 v4, 3, v1
    v_sub_u32 v4, 3, v4
    v_lshlrev_b32 v3, 3, v3
    v_lshlrev_b32 v5, 4, v2
    v_sub_u32 v3, v5, v3
    s_sub_u32 s6, 1, s49
    s_lshl_b32 s6, s6, 8
    s_add_u32 s6, s6, s14
    v_lshlrev_b32 v5, 6, v4
    v_lshlrev_b32 v4, 12, v4
    v_add_u32 v4, s6, v4
    v_add_u32 v6, 216, v3
    v_xor_b32 v6, v6, v5
    v_add_u32 v112, v6, v4
    v_add_u32 v6, 224, v3
    v_xor_b32 v6, v6, v5
    v_add_u32 v113, v6, v4
    v_add_u32 v6, 152, v3
    v_xor_b32 v6, v6, v5
    v_add_u32 v114, v6, v4
    v_add_u32 v6, 160, v3
    v_xor_b32 v6, v6, v5
    v_add_u32 v115, v6, v4
    v_add_u32 v6, 88, v3
    v_xor_b32 v6, v6, v5
    v_add_u32 v116, v6, v4
    v_add_u32 v6, 96, v3
    v_xor_b32 v6, v6, v5
    v_add_u32 v117, v6, v4
    v_add_u32 v6, 24, v3
    v_xor_b32 v6, v6, v5
    v_add_u32 v118, v6, v4
    v_add_u32 v6, 32, v3
    v_xor_b32 v6, v6, v5
    v_add_u32 v119, v6, v4
    s_lshl_b32 s7, s49, 8
    v_lshlrev_b32 v3, 5, v1
    v_lshl_add_u32 v3, v2, 4, v3
    v_subrev_u32 v10, s7, v3
    s_sub_u32 s6, s15, 288
    v_add_u32 v11, s6, v10
    v_mov_b32 v12, 0
    s_cmp_eq_u32 s49, 0
    s_cselect_b32 s77, 0x00ff0000, 0
    s_cselect_b32 s79, 0x0fff000f, 0
    s_mov_b32 s76, 0
    s_mov_b32 s78, 0
    s_waitcnt lgkmcnt(0)
    s_barrier
    s_cmp_lt_u32 s4, 14
    s_cbranch_scc1 conv_lo_41
    ds_read_b64 v[32:33], v112 offset:3584
    ds_read_b64 v[34:35], v113 offset:3584
    ds_read_b128 v[64:67], v11 offset:256
    ds_read_b64 v[36:37], v112 offset:3072
    ds_read_b64 v[38:39], v113 offset:3072
    ds_read_b128 v[68:71], v11 offset:768
    ds_read_b64 v[40:41], v112 offset:2560
    ds_read_b64 v[42:43], v113 offset:2560
    ds_read_b128 v[72:75], v11 offset:1280
    ds_read_b64 v[44:45], v112 offset:2048
    ds_read_b64 v[46:47], v113 offset:2048
    ds_read_b128 v[76:79], v11 offset:1792
    ds_read_b64 v[48:49], v112 offset:1536
    ds_read_b64 v[50:51], v113 offset:1536
    ds_read_b128 v[80:83], v11 offset:2304
    s_waitcnt lgkmcnt(12)
    ds_read_b64 v[52:53], v112 offset:1024
    ds_read_b64 v[54:55], v113 offset:1024
    ds_read_b128 v[84:87], v11 offset:2816
    s_waitcnt lgkmcnt(12)
    ds_read_b64 v[56:57], v112 offset:512
    ds_read_b64 v[58:59], v113 offset:512
    ds_read_b128 v[88:91], v11 offset:3328
    s_waitcnt lgkmcnt(12)
    ds_read_b64 v[60:61], v112 offset:0
    ds_read_b64 v[62:63], v113 offset:0
    ds_read_b128 v[92:95], v11 offset:3840
    v_cmp_gt_i32 vcc, 32, v10
    s_waitcnt lgkmcnt(0)
    s_nop 0
    v_cndmask_b32 v64, v64, v12, vcc
    v_cndmask_b32 v65, v65, v12, vcc
    v_cndmask_b32 v66, v66, v12, vcc
    v_cndmask_b32 v67, v67, v12, vcc
    s_mov_b64 exec, s[76:77]
    v_mov_b32 v32, 0
    v_mov_b32 v33, 0
    s_mov_b64 exec, s[78:79]
    v_mov_b32 v34, 0
    v_mov_b32 v35, 0
    s_mov_b64 exec, -1
    s_nop 0
    v_mfma_f32_16x16x32_bf16 v[96:99], v[32:35], v[92:95], 0
    v_mfma_f32_16x16x32_bf16 v[100:103], v[32:35], v[88:91], 0
    ds_read_b128 v[92:95], v11 offset:3776
    v_mfma_f32_16x16x32_bf16 v[104:107], v[32:35], v[84:87], 0
    v_mfma_f32_16x16x32_bf16 v[108:111], v[32:35], v[80:83], 0
    v_mfma_f32_16x16x32_bf16 v[96:99], v[36:39], v[88:91], v[96:99]
    ds_read_b64 v[32:33], v114 offset:3584
    ds_read_b64 v[34:35], v115 offset:3584
    v_mfma_f32_16x16x32_bf16 v[100:103], v[36:39], v[84:87], v[100:103]
    ds_read_b128 v[88:91], v11 offset:3264
    v_mfma_f32_16x16x32_bf16 v[104:107], v[36:39], v[80:83], v[104:107]
    v_mfma_f32_16x16x32_bf16 v[108:111], v[36:39], v[76:79], v[108:111]
    v_mfma_f32_16x16x32_bf16 v[96:99], v[40:43], v[84:87], v[96:99]
    ds_read_b64 v[36:37], v114 offset:3072
    ds_read_b64 v[38:39], v115 offset:3072
    v_mfma_f32_16x16x32_bf16 v[100:103], v[40:43], v[80:83], v[100:103]
    ds_read_b128 v[84:87], v11 offset:2752
    v_mfma_f32_16x16x32_bf16 v[104:107], v[40:43], v[76:79], v[104:107]
    v_mfma_f32_16x16x32_bf16 v[108:111], v[40:43], v[72:75], v[108:111]
    v_mfma_f32_16x16x32_bf16 v[96:99], v[44:47], v[80:83], v[96:99]
    ds_read_b64 v[40:41], v114 offset:2560
    ds_read_b64 v[42:43], v115 offset:2560
    v_mfma_f32_16x16x32_bf16 v[100:103], v[44:47], v[76:79], v[100:103]
    ds_read_b128 v[80:83], v11 offset:2240
    v_mfma_f32_16x16x32_bf16 v[104:107], v[44:47], v[72:75], v[104:107]
    v_mfma_f32_16x16x32_bf16 v[108:111], v[44:47], v[68:71], v[108:111]
    v_mfma_f32_16x16x32_bf16 v[96:99], v[48:51], v[76:79], v[96:99]
    ds_read_b64 v[44:45], v114 offset:2048
    ds_read_b64 v[46:47], v115 offset:2048
    v_mfma_f32_16x16x32_bf16 v[100:103], v[48:51], v[72:75], v[100:103]
    ds_read_b128 v[76:79], v11 offset:1728
    v_mfma_f32_16x16x32_bf16 v[104:107], v[48:51], v[68:71], v[104:107]
    v_mfma_f32_16x16x32_bf16 v[108:111], v[48:51], v[64:67], v[108:111]
    v_mfma_f32_16x16x32_bf16 v[96:99], v[52:55], v[72:75], v[96:99]
    ds_read_b64 v[48:49], v114 offset:1536
    ds_read_b64 v[50:51], v115 offset:1536
    v_mfma_f32_16x16x32_bf16 v[100:103], v[52:55], v[68:71], v[100:103]
    s_waitcnt lgkmcnt(12)
    ds_read_b128 v[72:75], v11 offset:1216
    v_mfma_f32_16x16x32_bf16 v[104:107], v[52:55], v[64:67], v[104:107]
    v_mfma_f32_16x16x32_bf16 v[96:99], v[56:59], v[68:71], v[96:99]
    ds_read_b64 v[52:53], v114 offset:1024
    ds_read_b64 v[54:55], v115 offset:1024
    v_mfma_f32_16x16x32_bf16 v[100:103], v[56:59], v[64:67], v[100:103]
    s_waitcnt lgkmcnt(12)
    ds_read_b128 v[68:71], v11 offset:704
    v_mfma_f32_16x16x32_bf16 v[96:99], v[60:63], v[64:67], v[96:99]
    ds_read_b64 v[56:57], v114 offset:512
    ds_read_b64 v[58:59], v115 offset:512
    s_nop 3
    s_waitcnt lgkmcnt(12)
    ds_read_b64 v[60:61], v114 offset:0
    ds_read_b64 v[62:63], v115 offset:0
    ds_read_b128 v[64:67], v11 offset:192
    v_cmp_gt_i32 vcc, 96, v10
    s_waitcnt lgkmcnt(0)
    s_nop 0
    v_cndmask_b32 v64, v64, v12, vcc
    v_cndmask_b32 v65, v65, v12, vcc
    v_cndmask_b32 v66, v66, v12, vcc
    v_cndmask_b32 v67, v67, v12, vcc
    v_mfma_f32_16x16x32_bf16 v[96:99], v[32:35], v[92:95], v[96:99]
    v_mfma_f32_16x16x32_bf16 v[100:103], v[32:35], v[88:91], v[100:103]
    ds_read_b128 v[92:95], v11 offset:3712
    v_mfma_f32_16x16x32_bf16 v[104:107], v[32:35], v[84:87], v[104:107]
    v_mfma_f32_16x16x32_bf16 v[108:111], v[32:35], v[80:83], v[108:111]
    v_mfma_f32_16x16x32_bf16 v[96:99], v[36:39], v[88:91], v[96:99]
    ds_read_b64 v[32:33], v116 offset:3584
    ds_read_b64 v[34:35], v117 offset:3584
    v_mfma_f32_16x16x32_bf16 v[100:103], v[36:39], v[84:87], v[100:103]
    ds_read_b128 v[88:91], v11 offset:3200
    v_mfma_f32_16x16x32_bf16 v[104:107], v[36:39], v[80:83], v[104:107]
    v_mfma_f32_16x16x32_bf16 v[108:111], v[36:39], v[76:79], v[108:111]
    v_mfma_f32_16x16x32_bf16 v[96:99], v[40:43], v[84:87], v[96:99]
    ds_read_b64 v[36:37], v116 offset:3072
    ds_read_b64 v[38:39], v117 offset:3072
    v_mfma_f32_16x16x32_bf16 v[100:103], v[40:43], v[80:83], v[100:103]
    ds_read_b128 v[84:87], v11 offset:2688
    v_mfma_f32_16x16x32_bf16 v[104:107], v[40:43], v[76:79], v[104:107]
    v_mfma_f32_16x16x32_bf16 v[108:111], v[40:43], v[72:75], v[108:111]
    v_mfma_f32_16x16x32_bf16 v[96:99], v[44:47], v[80:83], v[96:99]
    ds_read_b64 v[40:41], v116 offset:2560
    ds_read_b64 v[42:43], v117 offset:2560
    v_mfma_f32_16x16x32_bf16 v[100:103], v[44:47], v[76:79], v[100:103]
    ds_read_b128 v[80:83], v11 offset:2176
    v_mfma_f32_16x16x32_bf16 v[104:107], v[44:47], v[72:75], v[104:107]
    v_mfma_f32_16x16x32_bf16 v[108:111], v[44:47], v[68:71], v[108:111]
    v_mfma_f32_16x16x32_bf16 v[96:99], v[48:51], v[76:79], v[96:99]
    ds_read_b64 v[44:45], v116 offset:2048
    ds_read_b64 v[46:47], v117 offset:2048
    v_mfma_f32_16x16x32_bf16 v[100:103], v[48:51], v[72:75], v[100:103]
    ds_read_b128 v[76:79], v11 offset:1664
    v_mfma_f32_16x16x32_bf16 v[104:107], v[48:51], v[68:71], v[104:107]
    v_mfma_f32_16x16x32_bf16 v[108:111], v[48:51], v[64:67], v[108:111]
    v_mfma_f32_16x16x32_bf16 v[96:99], v[52:55], v[72:75], v[96:99]
    ds_read_b64 v[48:49], v116 offset:1536
    ds_read_b64 v[50:51], v117 offset:1536
    v_mfma_f32_16x16x32_bf16 v[100:103], v[52:55], v[68:71], v[100:103]
    s_waitcnt lgkmcnt(12)
    ds_read_b128 v[72:75], v11 offset:1152
    v_mfma_f32_16x16x32_bf16 v[104:107], v[52:55], v[64:67], v[104:107]
    v_mfma_f32_16x16x32_bf16 v[96:99], v[56:59], v[68:71], v[96:99]
    ds_read_b64 v[52:53], v116 offset:1024
    ds_read_b64 v[54:55], v117 offset:1024
    v_mfma_f32_16x16x32_bf16 v[100:103], v[56:59], v[64:67], v[100:103]
    s_waitcnt lgkmcnt(12)
    ds_read_b128 v[68:71], v11 offset:640
    v_mfma_f32_16x16x32_bf16 v[96:99], v[60:63], v[64:67], v[96:99]
    ds_read_b64 v[56:57], v116 offset:512
    ds_read_b64 v[58:59], v117 offset:512
    s_nop 3
    s_waitcnt lgkmcnt(12)
    ds_read_b64 v[60:61], v116 offset:0
    ds_read_b64 v[62:63], v117 offset:0
    ds_read_b128 v[64:67], v11 offset:128
    v_cmp_gt_i32 vcc, 160, v10
    s_waitcnt lgkmcnt(0)
    s_nop 0
    v_cndmask_b32 v64, v64, v12, vcc
    v_cndmask_b32 v65, v65, v12, vcc
    v_cndmask_b32 v66, v66, v12, vcc
    v_cndmask_b32 v67, v67, v12, vcc
    v_mfma_f32_16x16x32_bf16 v[96:99], v[32:35], v[92:95], v[96:99]
    v_mfma_f32_16x16x32_bf16 v[100:103], v[32:35], v[88:91], v[100:103]
    ds_read_b128 v[92:95], v11 offset:3648
    v_mfma_f32_16x16x32_bf16 v[104:107], v[32:35], v[84:87], v[104:107]
    v_mfma_f32_16x16x32_bf16 v[108:111], v[32:35], v[80:83], v[108:111]
    v_mfma_f32_16x16x32_bf16 v[96:99], v[36:39], v[88:91], v[96:99]
    ds_read_b64 v[32:33], v118 offset:3584
    ds_read_b64 v[34:35], v119 offset:3584
    v_mfma_f32_16x16x32_bf16 v[100:103], v[36:39], v[84:87], v[100:103]
    ds_read_b128 v[88:91], v11 offset:3136
    v_mfma_f32_16x16x32_bf16 v[104:107], v[36:39], v[80:83], v[104:107]
    v_mfma_f32_16x16x32_bf16 v[108:111], v[36:39], v[76:79], v[108:111]
    v_mfma_f32_16x16x32_bf16 v[96:99], v[40:43], v[84:87], v[96:99]
    ds_read_b64 v[36:37], v118 offset:3072
    ds_read_b64 v[38:39], v119 offset:3072
    v_mfma_f32_16x16x32_bf16 v[100:103], v[40:43], v[80:83], v[100:103]
    ds_read_b128 v[84:87], v11 offset:2624
    v_mfma_f32_16x16x32_bf16 v[104:107], v[40:43], v[76:79], v[104:107]
    v_mfma_f32_16x16x32_bf16 v[108:111], v[40:43], v[72:75], v[108:111]
    v_mfma_f32_16x16x32_bf16 v[96:99], v[44:47], v[80:83], v[96:99]
    ds_read_b64 v[40:41], v118 offset:2560
    ds_read_b64 v[42:43], v119 offset:2560
    v_mfma_f32_16x16x32_bf16 v[100:103], v[44:47], v[76:79], v[100:103]
    ds_read_b128 v[80:83], v11 offset:2112
    v_mfma_f32_16x16x32_bf16 v[104:107], v[44:47], v[72:75], v[104:107]
    v_mfma_f32_16x16x32_bf16 v[108:111], v[44:47], v[68:71], v[108:111]
    v_mfma_f32_16x16x32_bf16 v[96:99], v[48:51], v[76:79], v[96:99]
    ds_read_b64 v[44:45], v118 offset:2048
    ds_read_b64 v[46:47], v119 offset:2048
    v_mfma_f32_16x16x32_bf16 v[100:103], v[48:51], v[72:75], v[100:103]
    ds_read_b128 v[76:79], v11 offset:1600
    v_mfma_f32_16x16x32_bf16 v[104:107], v[48:51], v[68:71], v[104:107]
    v_mfma_f32_16x16x32_bf16 v[108:111], v[48:51], v[64:67], v[108:111]
    v_mfma_f32_16x16x32_bf16 v[96:99], v[52:55], v[72:75], v[96:99]
    ds_read_b64 v[48:49], v118 offset:1536
    ds_read_b64 v[50:51], v119 offset:1536
    v_mfma_f32_16x16x32_bf16 v[100:103], v[52:55], v[68:71], v[100:103]
    s_waitcnt lgkmcnt(12)
    ds_read_b128 v[72:75], v11 offset:1088
    v_mfma_f32_16x16x32_bf16 v[104:107], v[52:55], v[64:67], v[104:107]
    v_mfma_f32_16x16x32_bf16 v[96:99], v[56:59], v[68:71], v[96:99]
    ds_read_b64 v[52:53], v118 offset:1024
    ds_read_b64 v[54:55], v119 offset:1024
    v_mfma_f32_16x16x32_bf16 v[100:103], v[56:59], v[64:67], v[100:103]
    s_waitcnt lgkmcnt(12)
    ds_read_b128 v[68:71], v11 offset:576
    v_mfma_f32_16x16x32_bf16 v[96:99], v[60:63], v[64:67], v[96:99]
    ds_read_b64 v[56:57], v118 offset:512
    ds_read_b64 v[58:59], v119 offset:512
    s_nop 3
    s_waitcnt lgkmcnt(12)
    ds_read_b64 v[60:61], v118 offset:0
    ds_read_b64 v[62:63], v119 offset:0
    ds_read_b128 v[64:67], v11 offset:64
    v_cmp_gt_i32 vcc, 224, v10
    s_waitcnt lgkmcnt(0)
    s_nop 0
    v_cndmask_b32 v64, v64, v12, vcc
    v_cndmask_b32 v65, v65, v12, vcc
    v_cndmask_b32 v66, v66, v12, vcc
    v_cndmask_b32 v67, v67, v12, vcc
    v_mfma_f32_16x16x32_bf16 v[96:99], v[32:35], v[92:95], v[96:99]
    v_mfma_f32_16x16x32_bf16 v[100:103], v[32:35], v[88:91], v[100:103]
    v_mfma_f32_16x16x32_bf16 v[104:107], v[32:35], v[84:87], v[104:107]
    v_mfma_f32_16x16x32_bf16 v[108:111], v[32:35], v[80:83], v[108:111]
    v_mfma_f32_16x16x32_bf16 v[96:99], v[36:39], v[88:91], v[96:99]
    v_mfma_f32_16x16x32_bf16 v[100:103], v[36:39], v[84:87], v[100:103]
    v_mfma_f32_16x16x32_bf16 v[104:107], v[36:39], v[80:83], v[104:107]
    v_mfma_f32_16x16x32_bf16 v[108:111], v[36:39], v[76:79], v[108:111]
    v_mfma_f32_16x16x32_bf16 v[96:99], v[40:43], v[84:87], v[96:99]
    v_mfma_f32_16x16x32_bf16 v[100:103], v[40:43], v[80:83], v[100:103]
    v_mfma_f32_16x16x32_bf16 v[104:107], v[40:43], v[76:79], v[104:107]
    v_mfma_f32_16x16x32_bf16 v[108:111], v[40:43], v[72:75], v[108:111]
    v_mfma_f32_16x16x32_bf16 v[96:99], v[44:47], v[80:83], v[96:99]
    v_mfma_f32_16x16x32_bf16 v[100:103], v[44:47], v[76:79], v[100:103]
    v_mfma_f32_16x16x32_bf16 v[104:107], v[44:47], v[72:75], v[104:107]
    v_mfma_f32_16x16x32_bf16 v[108:111], v[44:47], v[68:71], v[108:111]
    v_mfma_f32_16x16x32_bf16 v[96:99], v[48:51], v[76:79], v[96:99]
    v_mfma_f32_16x16x32_bf16 v[100:103], v[48:51], v[72:75], v[100:103]
    v_mfma_f32_16x16x32_bf16 v[104:107], v[48:51], v[68:71], v[104:107]
    v_mfma_f32_16x16x32_bf16 v[108:111], v[48:51], v[64:67], v[108:111]
    v_mfma_f32_16x16x32_bf16 v[96:99], v[52:55], v[72:75], v[96:99]
    v_mfma_f32_16x16x32_bf16 v[100:103], v[52:55], v[68:71], v[100:103]
    v_mfma_f32_16x16x32_bf16 v[104:107], v[52:55], v[64:67], v[104:107]
    v_mfma_f32_16x16x32_bf16 v[96:99], v[56:59], v[68:71], v[96:99]
    v_mfma_f32_16x16x32_bf16 v[100:103], v[56:59], v[64:67], v[100:103]
    v_mfma_f32_16x16x32_bf16 v[96:99], v[60:63], v[64:67], v[96:99]
    s_mov_b32 s76, 0x04050607
    s_branch conv_out_42
conv_lo_41:
    ds_read_b64 v[32:33], v112 offset:3584
    ds_read_b64 v[34:35], v113 offset:3584
    ds_read_b128 v[64:67], v11 offset:256
    ds_read_b64 v[36:37], v112 offset:3072
    ds_read_b64 v[38:39], v113 offset:3072
    ds_read_b128 v[68:71], v11 offset:768
    ds_read_b64 v[40:41], v112 offset:2560
    ds_read_b64 v[42:43], v113 offset:2560
    ds_read_b128 v[72:75], v11 offset:1280
    ds_read_b64 v[44:45], v112 offset:2048
    ds_read_b64 v[46:47], v113 offset:2048
    ds_read_b128 v[76:79], v11 offset:1792
    v_cmp_gt_i32 vcc, 32, v10
    s_waitcnt lgkmcnt(0)
    s_nop 0
    v_cndmask_b32 v64, v64, v12, vcc
    v_cndmask_b32 v65, v65, v12, vcc
    v_cndmask_b32 v66, v66, v12, vcc
    v_cndmask_b32 v67, v67, v12, vcc
    s_mov_b64 exec, s[76:77]
    v_mov_b32 v32, 0
    v_mov_b32 v33, 0
    s_mov_b64 exec, s[78:79]
    v_mov_b32 v34, 0
    v_mov_b32 v35, 0
    s_mov_b64 exec, -1
    s_nop 0
    v_mfma_f32_16x16x32_bf16 v[96:99], v[32:35], v[76:79], 0
    v_mfma_f32_16x16x32_bf16 v[100:103], v[32:35], v[72:75], 0
    ds_read_b128 v[76:79], v11 offset:1728
    v_mfma_f32_16x16x32_bf16 v[104:107], v[32:35], v[68:71], 0
    v_mfma_f32_16x16x32_bf16 v[108:111], v[32:35], v[64:67], 0
    v_mfma_f32_16x16x32_bf16 v[96:99], v[36:39], v[72:75], v[96:99]
    ds_read_b64 v[32:33], v114 offset:3584
    ds_read_b64 v[34:35], v115 offset:3584
    v_mfma_f32_16x16x32_bf16 v[100:103], v[36:39], v[68:71], v[100:103]
    ds_read_b128 v[72:75], v11 offset:1216
    v_mfma_f32_16x16x32_bf16 v[104:107], v[36:39], v[64:67], v[104:107]
    v_mfma_f32_16x16x32_bf16 v[96:99], v[40:43], v[68:71], v[96:99]
    ds_read_b64 v[36:37], v114 offset:3072
    ds_read_b64 v[38:39], v115 offset:3072
    v_mfma_f32_16x16x32_bf16 v[100:103], v[40:43], v[64:67], v[100:103]
    ds_read_b128 v[68:71], v11 offset:704
    v_mfma_f32_16x16x32_bf16 v[96:99], v[44:47], v[64:67], v[96:99]
    ds_read_b64 v[40:41], v114 offset:2560
    ds_read_b64 v[42:43], v115 offset:2560
    s_nop 3
    ds_read_b64 v[44:45], v114 offset:2048
    ds_read_b64 v[46:47], v115 offset:2048
    ds_read_b128 v[64:67], v11 offset:192
    v_cmp_gt_i32 vcc, 96, v10
    s_waitcnt lgkmcnt(0)
    s_nop 0
    v_cndmask_b32 v64, v64, v12, vcc
    v_cndmask_b32 v65, v65, v12, vcc
    v_cndmask_b32 v66, v66, v12, vcc
    v_cndmask_b32 v67, v67, v12, vcc
    v_mfma_f32_16x16x32_bf16 v[96:99], v[32:35], v[76:79], v[96:99]
    v_mfma_f32_16x16x32_bf16 v[100:103], v[32:35], v[72:75], v[100:103]
    ds_read_b128 v[76:79], v11 offset:1664
    v_mfma_f32_16x16x32_bf16 v[104:107], v[32:35], v[68:71], v[104:107]
    v_mfma_f32_16x16x32_bf16 v[108:111], v[32:35], v[64:67], v[108:111]
    v_mfma_f32_16x16x32_bf16 v[96:99], v[36:39], v[72:75], v[96:99]
    ds_read_b64 v[32:33], v116 offset:3584
    ds_read_b64 v[34:35], v117 offset:3584
    v_mfma_f32_16x16x32_bf16 v[100:103], v[36:39], v[68:71], v[100:103]
    ds_read_b128 v[72:75], v11 offset:1152
    v_mfma_f32_16x16x32_bf16 v[104:107], v[36:39], v[64:67], v[104:107]
    v_mfma_f32_16x16x32_bf16 v[96:99], v[40:43], v[68:71], v[96:99]
    ds_read_b64 v[36:37], v116 offset:3072
    ds_read_b64 v[38:39], v117 offset:3072
    v_mfma_f32_16x16x32_bf16 v[100:103], v[40:43], v[64:67], v[100:103]
    ds_read_b128 v[68:71], v11 offset:640
    v_mfma_f32_16x16x32_bf16 v[96:99], v[44:47], v[64:67], v[96:99]
    ds_read_b64 v[40:41], v116 offset:2560
    ds_read_b64 v[42:43], v117 offset:2560
    s_nop 3
    ds_read_b64 v[44:45], v116 offset:2048
    ds_read_b64 v[46:47], v117 offset:2048
    ds_read_b128 v[64:67], v11 offset:128
    v_cmp_gt_i32 vcc, 160, v10
    s_waitcnt lgkmcnt(0)
    s_nop 0
    v_cndmask_b32 v64, v64, v12, vcc
    v_cndmask_b32 v65, v65, v12, vcc
    v_cndmask_b32 v66, v66, v12, vcc
    v_cndmask_b32 v67, v67, v12, vcc
    v_mfma_f32_16x16x32_bf16 v[96:99], v[32:35], v[76:79], v[96:99]
    v_mfma_f32_16x16x32_bf16 v[100:103], v[32:35], v[72:75], v[100:103]
    ds_read_b128 v[76:79], v11 offset:1600
    v_mfma_f32_16x16x32_bf16 v[104:107], v[32:35], v[68:71], v[104:107]
    v_mfma_f32_16x16x32_bf16 v[108:111], v[32:35], v[64:67], v[108:111]
    v_mfma_f32_16x16x32_bf16 v[96:99], v[36:39], v[72:75], v[96:99]
    ds_read_b64 v[32:33], v118 offset:3584
    ds_read_b64 v[34:35], v119 offset:3584
    v_mfma_f32_16x16x32_bf16 v[100:103], v[36:39], v[68:71], v[100:103]
    ds_read_b128 v[72:75], v11 offset:1088
    v_mfma_f32_16x16x32_bf16 v[104:107], v[36:39], v[64:67], v[104:107]
    v_mfma_f32_16x16x32_bf16 v[96:99], v[40:43], v[68:71], v[96:99]
    ds_read_b64 v[36:37], v118 offset:3072
    ds_read_b64 v[38:39], v119 offset:3072
    v_mfma_f32_16x16x32_bf16 v[100:103], v[40:43], v[64:67], v[100:103]
    ds_read_b128 v[68:71], v11 offset:576
    v_mfma_f32_16x16x32_bf16 v[96:99], v[44:47], v[64:67], v[96:99]
    ds_read_b64 v[40:41], v118 offset:2560
    ds_read_b64 v[42:43], v119 offset:2560
    s_nop 3
    ds_read_b64 v[44:45], v118 offset:2048
    ds_read_b64 v[46:47], v119 offset:2048
    ds_read_b128 v[64:67], v11 offset:64
    v_cmp_gt_i32 vcc, 224, v10
    s_waitcnt lgkmcnt(0)
    s_nop 0
    v_cndmask_b32 v64, v64, v12, vcc
    v_cndmask_b32 v65, v65, v12, vcc
    v_cndmask_b32 v66, v66, v12, vcc
    v_cndmask_b32 v67, v67, v12, vcc
    v_mfma_f32_16x16x32_bf16 v[96:99], v[32:35], v[76:79], v[96:99]
    v_mfma_f32_16x16x32_bf16 v[100:103], v[32:35], v[72:75], v[100:103]
    v_mfma_f32_16x16x32_bf16 v[104:107], v[32:35], v[68:71], v[104:107]
    v_mfma_f32_16x16x32_bf16 v[108:111], v[32:35], v[64:67], v[108:111]
    v_mfma_f32_16x16x32_bf16 v[96:99], v[36:39], v[72:75], v[96:99]
    v_mfma_f32_16x16x32_bf16 v[100:103], v[36:39], v[68:71], v[100:103]
    v_mfma_f32_16x16x32_bf16 v[104:107], v[36:39], v[64:67], v[104:107]
    v_mfma_f32_16x16x32_bf16 v[96:99], v[40:43], v[68:71], v[96:99]
    v_mfma_f32_16x16x32_bf16 v[100:103], v[40:43], v[64:67], v[100:103]
    v_mfma_f32_16x16x32_bf16 v[96:99], v[44:47], v[64:67], v[96:99]
    s_mov_b32 s76, 0x00010203
conv_out_42:
    s_nop 7
    s_setprio 3
    s_barrier
    s_lshl_b32 s6, s5, 11
    v_add_u32 v3, s6, v8
    s_xor_b32 s6, s5, 4
    s_lshl_b32 s6, s6, 11
    v_add_u32 v4, s6, v8
    s_cmp_eq_u32 s49, 0
    s_cbranch_scc1 x1_43
    ds_write_b128 v3, v[96:99] offset:0
    ds_write_b128 v3, v[100:103] offset:1024
    s_nop 3
    v_mov_b32 v96, v104
    v_mov_b32 v97, v105
    v_mov_b32 v98, v106
    v_mov_b32 v99, v107
    v_mov_b32 v100, v108
    v_mov_b32 v101, v109
    v_mov_b32 v102, v110
    v_mov_b32 v103, v111
    s_branch x2_44
x1_43:
    ds_write_b128 v3, v[104:107] offset:0
    ds_write_b128 v3, v[108:111] offset:1024
x2_44:
    s_waitcnt lgkmcnt(0)
    s_barrier
    ds_read_b128 v[32:35], v4 offset:0
    ds_read_b128 v[36:39], v4 offset:1024
    v_lshlrev_b32 v3, 5, v1
    v_lshl_add_u32 v3, v2, 3, v3
    s_mul_i32 s6, s48, 2112
    s_lshl_b32 s7, s49, 10
    s_add_u32 s6, s6, s7
    s_add_u32 s6, s6, 32768
    v_add_u32 v3, s6, v3
    v_bfe_u32 v5, v7, 2, 2
    v_mul_u32_u24 v5, 2112, v5
    v_lshl_add_u32 v5, v2, 5, v5
    v_and_b32 v4, 3, v7
    v_lshl_add_u32 v5, v4, 3, v5
    s_lshl_b32 s6, s5, 8
    s_add_u32 s6, s6, 32768
    v_add_u32 v5, s6, v5
    s_lshr_b32 s6, s5, 1
    s_lshl_b32 s6, s6, 3
    s_lshr_b32 s6, s76, s6
    s_and_b32 s6, s6, 0xff
    s_lshl_b32 s6, s6, 1
    s_and_b32 s7, s5, 1
    s_add_u32 s6, s6, s7
    s_mul_i32 s6, s6, 229376
    s_lshl_b32 s7, s11, 3
    s_add_u32 s6, s6, s7
    s_add_u32 s6, s6, 896
    s_add_u32 s7, s6, 114688
    v_mul_u32_u24 v4, 1792, v7
    s_waitcnt lgkmcnt(0)
    v_pk_add_f32 v[96:97], v[96:97], v[32:33]
    v_pk_add_f32 v[98:99], v[98:99], v[34:35]
    v_pk_add_f32 v[100:101], v[100:101], v[36:37]
    v_pk_add_f32 v[102:103], v[102:103], v[38:39]
    v_cvt_pk_bf16_f32 v40, v96, v97
    v_cvt_pk_bf16_f32 v41, v98, v99
    v_cvt_pk_bf16_f32 v42, v100, v101
    v_cvt_pk_bf16_f32 v43, v102, v103
    ds_write_b64 v3, v[40:41] offset:0
    ds_write_b64 v3, v[42:43] offset:512
    s_waitcnt lgkmcnt(0)
    s_barrier
    ds_read_b64_tr_b16 v[44:45], v5 offset:0
    ds_read_b64_tr_b16 v[46:47], v5 offset:128
    s_waitcnt lgkmcnt(1)
    buffer_store_dwordx2 v[44:45], v4, s[60:63], s6 offen
    s_waitcnt lgkmcnt(0)
    buffer_store_dwordx2 v[46:47], v4, s[60:63], s7 offen
K_exit:
    s_endpgm
CODE_END:
.section .rodata,"a"
.p2align 6
.amdhsa_kernel concat_heads__linear_attn_block__ssm_conv_s4d__prompt_kernel
  .amdhsa_next_free_vgpr 128
  .amdhsa_next_free_sgpr 102
  .amdhsa_accum_offset 128
  .amdhsa_group_segment_fixed_size 0
  .amdhsa_kernarg_size 104
  .amdhsa_user_sgpr_count 2
  .amdhsa_user_sgpr_kernarg_segment_ptr 1
  .amdhsa_system_sgpr_workgroup_id_x 1
.end_amdhsa_kernel
```
